```python
import torch

def _softmax(x, axis=-1):
    return torch.softmax(x, dim=axis)
def _gelu(x):
    return torch.nn.functional.gelu(x, approximate="tanh")
def _silu(x):
    return torch.nn.functional.silu(x)
def _sigmoid(x):
    return torch.sigmoid(x)
def _layernorm(x, axis=-1, eps=1e-5):
    m = x.mean(dim=axis, keepdim=True)
    v = x.var(dim=axis, keepdim=True, unbiased=False)
    return (x - m) / torch.sqrt(v + eps)
def _scatter_add(tgt, idx, src, axis=0):
    return tgt.clone().index_add_(axis, idx, src)
def _segment_sum(src, seg, n):
    out = torch.zeros((n,) + src.shape[1:], dtype=src.dtype)
    return out.index_add_(0, seg, src)
def _pad(x, pw):
    flat = tuple(v for pair in reversed(pw) for v in pair)
    return torch.nn.functional.pad(x, flat)

kernel_name = 'sequential_preLN__sliding_local_dilated__glu_gated_glu__prompt'

def setup_inputs():

    _w = (lambda a: (lambda t: t.to(torch.bfloat16) if t.is_floating_point() else t)(torch.as_tensor(a)))
    def _A_setup():
        B, S, D = 1, 2048, 448
        return {
            "x": _w((lambda *s: torch.randn(*s, dtype=torch.bfloat16) * 0.05)(B, S, D)),
            "wqkv": _w((lambda *s: torch.randn(*s, dtype=torch.bfloat16) * 0.05)(D, 3 * D)),
            "wo": _w((lambda *s: torch.randn(*s, dtype=torch.bfloat16) * 0.05)(D, D)),
        }
    _A_in = _A_setup()

    def _B_setup():
        B, S, D, F = 1, 2048, 448, 1792
        return {
            "x": _w((lambda *s: torch.randn(*s, dtype=torch.bfloat16) * 0.05)(B, S, D)),
            "w_gate": _w((lambda *s: torch.randn(*s, dtype=torch.bfloat16) * 0.05)(D, F)),
            "w_up": _w((lambda *s: torch.randn(*s, dtype=torch.bfloat16) * 0.05)(D, F)),
            "w_down": _w((lambda *s: torch.randn(*s, dtype=torch.bfloat16) * 0.05)(F, D)),
        }
    _B_in = _B_setup()

    return {
        "A_x": _A_in["x"],
        "A_wqkv": _A_in["wqkv"],
        "A_wo": _A_in["wo"],
        "B_x": _B_in["x"],
        "B_w_gate": _B_in["w_gate"],
        "B_w_up": _B_in["w_up"],
        "B_w_down": _B_in["w_down"],
    }

def reference(A_x, A_wqkv, A_wo, B_x, B_w_gate, B_w_up, B_w_down):
    def _A_ref(x, wqkv, wo):
        B, S, D = x.shape
        H = 16; Dh = D // H
        W, dil = 8, 2
        qkv = (lambda x, *d: x.permute(*d))((x @ wqkv).reshape(B, S, 3, H, Dh), 2, 0, 3, 1, 4)
        q, k, v = qkv[0], qkv[1], qkv[2]
        scale = Dh ** -0.5
        pos = torch.arange(S)
        off = torch.arange(W) * dil
        idx = pos[:, None] - off[None, :]
        mask = idx >= 0
        idx_c = torch.where(mask, idx, 0).reshape(-1)
        kg = k[:, :, idx_c, :].reshape(B, H, S, W, Dh)
        vg = v[:, :, idx_c, :].reshape(B, H, S, W, Dh)
        logits = torch.einsum("bhsd,bhswd->bhsw", q, kg) * scale
        logits = torch.where(mask[None, None, :, :], logits, -1e9)
        attn = _softmax(logits, axis=-1)
        o = torch.einsum("bhsw,bhswd->bhsd", attn, vg)
        return (lambda x, *d: x.permute(*d))(o, 0, 2, 1, 3).reshape(B, S, D) @ wo

    def _B_ref(x, w_gate, w_up, w_down):
        g = torch.einsum("bsd,df->bsf", x, w_gate)
        u = torch.einsum("bsd,df->bsf", x, w_up)
        h = _sigmoid(g) * u
        return torch.einsum("bsf,fd->bsd", h, w_down)

    x = A_x
    h = x + _A_ref(_layernorm(x, axis=-1), A_wqkv, A_wo)
    h2 = h + _B_ref(_layernorm(h, axis=-1), B_w_gate, B_w_up, B_w_down)
    return h2
```

```asm
; @launch grid=(256,1,1) block=(512,1,1) lds=163840
.amdgcn_target "amdgcn-amd-amdhsa--gfx950"
.text
.globl sequential_preLN__sliding_local_dilated__glu_gated_glu__prompt_kernel
.p2align 8
.type sequential_preLN__sliding_local_dilated__glu_gated_glu__prompt_kernel,@function
sequential_preLN__sliding_local_dilated__glu_gated_glu__prompt_kernel:
    s_cmp_ge_u32 s2, 256
    s_cbranch_scc1 L_end
    s_load_dwordx4 s[8:11], s[0:1], 0
    s_load_dwordx2 s[36:37], s[0:1], 72
    v_lshrrev_b32 v4, 6, v0
    v_and_b32 v1, 63, v0
    s_getpc_b64 s[88:89]
    s_and_b32 s90, s2, 0xf8
    v_lshl_add_u32 v5, v1, 8, v4
    v_add_u32 v5, s90, v5
    v_lshlrev_b32 v5, 7, v5
    v_min_u32 v5, 0x8758, v5
    s_mov_b64 exec, 3
    global_load_dword v31, v5, s[88:89]
    s_mov_b64 exec, -1
    v_readfirstlane_b32 s4, v4
    s_and_b32 s5, s2, 7
    s_lshr_b32 s6, s2, 3
    s_lshl_b32 s50, s5, 8
    s_lshl_b32 s54, s5, 14
    s_add_u32 s54, s54, 9437184
    v_lshrrev_b32 v3, 4, v1
    s_mov_b32 s38, 10485760
    s_mov_b32 s39, 0x00020000
    s_mov_b32 s14, 1204224
    s_mov_b32 s15, 0x00020000
    s_and_b32 s45, s4, 1
    s_cmp_ge_u32 s6, 16
    s_cbranch_scc1 L_roleb
    s_mov_b32 s60, 0xca875310
    s_mov_b32 s61, 0xfdb9642e
    s_lshl_b32 s62, s6, 2
    s_lshr_b64 s[60:61], s[60:61], s62
    s_and_b32 s48, s60, 15
    s_cmp_ge_u32 s4, 4
    s_cselect_b32 s60, 20, 0
    s_add_u32 s60, s60, s4
    s_lshl_b32 s59, s60, 10
    s_lshl_b32 s60, s60, 3
    s_add_u32 s60, s60, s50
    s_mul_i32 s60, s60, 896
    v_lshrrev_b32 v4, 3, v1
    v_mul_u32_u24 v8, 896, v4
    v_and_b32 v6, 7, v1
    v_xor_b32 v7, v6, v3
    s_lshl_b32 s61, s45, 2
    v_xor_b32 v7, s61, v7
    v_lshl_add_u32 v7, v7, 4, v8
    v_add_u32 v17, s60, v7
    v_subrev_u32 v19, 14336, v17
    v_lshrrev_b32 v4, 2, v1
    v_mul_u32_u24 v4, 2688, v4
    v_and_b32 v5, 2, v3
    v_and_b32 v9, 3, v1
    v_xor_b32 v5, v5, v9
    v_lshl_add_u32 v4, v5, 4, v4
    s_and_b32 s60, s4, 3
    s_mul_i32 s61, s60, 43008
    s_mul_i32 s62, s48, 56
    s_add_u32 s61, s61, s62
    v_add_u32 v18, s61, v4
    s_lshr_b32 s60, s60, 1
    s_mul_i32 s57, s60, 6656
    s_lshl_b32 s61, s45, 10
    s_add_u32 s57, s57, s61
    v_mov_b32 v5, 0
    s_waitcnt lgkmcnt(0)
    s_mov_b32 s12, s10
    s_mov_b32 s13, s11
    s_mov_b32 s10, 1835008
    s_mov_b32 s11, 0x00020000
    s_cmp_lt_u32 s4, 4
    s_cbranch_scc0 L_p1B_1
    s_add_u32 m0, s59, 73728
    s_movk_i32 s96, 0
    s_cmp_lt_u32 s4, 2
    s_cselect_b64 exec, -1, 0
    buffer_load_dwordx4 v19, s[8:11], s96 offen lds
    s_mov_b64 exec, -1
    s_add_u32 m0, s59, 40960
    s_mov_b32 s96, 0
    buffer_load_dwordx4 v17, s[8:11], s96 offen lds
    s_add_u32 m0, s59, 45056
    s_mov_b32 s96, 28672
    buffer_load_dwordx4 v17, s[8:11], s96 offen lds
    s_add_u32 m0, s59, 49152
    s_mov_b32 s96, 57344
    buffer_load_dwordx4 v17, s[8:11], s96 offen lds
    s_add_u32 m0, s59, 53248
    s_mov_b32 s96, 86016
    buffer_load_dwordx4 v17, s[8:11], s96 offen lds
    s_add_u32 m0, s59, 57344
    s_mov_b32 s96, 114688
    buffer_load_dwordx4 v17, s[8:11], s96 offen lds
    s_add_u32 m0, s59, 61440
    s_mov_b32 s96, 143360
    buffer_load_dwordx4 v17, s[8:11], s96 offen lds
    buffer_load_dword v14, v5, s[36:39], s54 offen sc1
    s_load_dwordx2 s[16:17], s[0:1], 16
    s_load_dwordx2 s[20:21], s[0:1], 32
    s_load_dwordx2 s[24:25], s[0:1], 40
    s_load_dwordx2 s[28:29], s[0:1], 48
    s_load_dwordx2 s[32:33], s[0:1], 56
    v_and_b32 v2, 15, v1
    s_lshr_b32 s44, s4, 1
    v_cmp_eq_u32 s[66:67], 0, v2
    v_bfe_u32 v4, v1, 2, 2
    v_lshl_add_u32 v4, v3, 3, v4
    v_lshlrev_b32 v4, 6, v4
    v_lshl_add_u32 v4, v9, 3, v4
    v_and_b32 v6, 1, v3
    v_lshl_add_u32 v7, v6, 5, v4
    v_cmp_eq_u32 s[70:71], 3, v9
    s_mul_i32 s62, s45, 3
    s_add_u32 s61, s44, 0
    s_cmp_ge_u32 s61, 3
    s_cselect_b32 s60, 3, 0
    s_sub_u32 s61, s61, s60
    s_add_u32 s63, s61, s62
    s_lshr_b32 s60, s63, 1
    s_lshl_b32 s90, s60, 3
    s_add_u32 s90, s90, 6144
    s_lshl_b32 s60, s60, 11
    s_and_b32 s61, s63, 1
    s_cselect_b64 vcc, s[70:71], 0
    s_lshl_b32 s61, s61, 5
    v_xor_b32 v11, s61, v7
    v_add_u32 v11, s60, v11
    v_mov_b32 v10, s90
    v_cndmask_b32 v20, v11, v10, vcc
    s_add_u32 s61, s44, 1
    s_cmp_ge_u32 s61, 3
    s_cselect_b32 s60, 3, 0
    s_sub_u32 s61, s61, s60
    s_add_u32 s64, s61, s62
    s_lshr_b32 s60, s64, 1
    s_lshl_b32 s90, s60, 3
    s_add_u32 s90, s90, 6144
    s_lshl_b32 s60, s60, 11
    s_and_b32 s61, s64, 1
    s_cselect_b64 vcc, s[70:71], 0
    s_lshl_b32 s61, s61, 5
    v_xor_b32 v11, s61, v7
    v_add_u32 v11, s60, v11
    v_mov_b32 v10, s90
    v_cndmask_b32 v21, v11, v10, vcc
    s_add_u32 s61, s44, 2
    s_cmp_ge_u32 s61, 3
    s_cselect_b32 s60, 3, 0
    s_sub_u32 s61, s61, s60
    s_add_u32 s65, s61, s62
    s_lshr_b32 s60, s65, 1
    s_lshl_b32 s90, s60, 3
    s_add_u32 s90, s90, 6144
    s_lshl_b32 s60, s60, 11
    s_and_b32 s61, s65, 1
    s_cselect_b64 vcc, s[70:71], 0
    s_lshl_b32 s61, s61, 5
    v_xor_b32 v11, s61, v7
    v_add_u32 v11, s60, v11
    v_mov_b32 v10, s90
    v_cndmask_b32 v22, v11, v10, vcc
    v_lshrrev_b32 v4, 1, v2
    v_xor_b32 v4, v4, v3
    v_lshlrev_b32 v4, 4, v4
    v_lshl_add_u32 v4, v2, 7, v4
    v_xor_b32 v5, 64, v4
    v_mov_b32 v10, 2048
    v_cndmask_b32 v6, v4, v10, s[66:67]
    v_cndmask_b32 v7, v5, v10, s[66:67]
    s_lshl_b32 s94, s4, 1
    s_xor_b32 s95, s94, 2
    s_lshl_b32 s60, s94, 11
    s_add_u32 s60, s60, 40960
    v_add_u32 v146, s60, v4
    v_add_u32 v148, s60, v5
    s_lshl_b32 s60, s95, 11
    s_add_u32 s60, s60, 40960
    v_add_u32 v147, s60, v4
    v_add_u32 v149, s60, v5
    v_add_u32 v158, 73728, v6
    v_add_u32 v159, 73728, v7
    s_lshl_b32 s60, s94, 11
    s_add_u32 s60, s60, 75904
    v_add_u32 v150, s60, v4
    v_add_u32 v152, s60, v5
    s_lshl_b32 s60, s95, 11
    s_add_u32 s60, s60, 75904
    v_add_u32 v151, s60, v4
    v_add_u32 v153, s60, v5
    v_add_u32 v160, 108672, v6
    v_add_u32 v161, 108672, v7
    s_lshl_b32 s60, s94, 11
    s_add_u32 s60, s60, 110848
    v_add_u32 v154, s60, v4
    v_add_u32 v156, s60, v5
    s_lshl_b32 s60, s95, 11
    s_add_u32 s60, s60, 110848
    v_add_u32 v155, s60, v4
    v_add_u32 v157, s60, v5
    v_add_u32 v162, 143616, v6
    v_add_u32 v163, 143616, v7
    v_lshrrev_b32 v4, 1, v1
    v_mul_u32_u24 v4, 6656, v4
    v_and_b32 v5, 1, v1
    v_lshl_add_u32 v4, v5, 8, v4
    v_mov_b32 v8, 0x3f80
    v_mov_b32 v9, 0
    v_mov_b32 v10, 0x3f800000
    v_mov_b32 v11, 0
    v_mov_b32 v6, 0
    v_mov_b32 v7, 0
    s_mov_b64 exec, 0xfff
    ds_write_b128 v4, v[8:11] offset:6144
    ds_write_b64 v4, v[6:7] offset:6160
    s_mov_b64 exec, 7
    v_mul_u32_u24 v4, 34944, v1
    v_add_u32 v4, 75776, v4
    v_mov_b32 v168, 0x3f803f80
    v_mov_b32 v169, 0x3f803f80
    v_mov_b32 v170, 0x3f803f80
    v_mov_b32 v171, 0x3f803f80
    ds_write_b128 v4, v[168:171]
    s_mov_b64 exec, -1
    s_getreg_b32 s101, hwreg(HW_REG_XCC_ID)
    s_and_b32 s101, s101, 15
    v_lshrrev_b32 v4, 3, v1
    v_lshlrev_b32 v4, 7, v4
    v_and_b32 v5, 7, v1
    v_lshl_add_u32 v124, v5, 2, v4
    v_add_u32 v124, 128, v124
    s_add_u32 m0, s59, 108672
    s_movk_i32 s96, 128
    s_cmp_lt_u32 s4, 2
    s_cselect_b64 exec, -1, 0
    buffer_load_dwordx4 v19, s[8:11], s96 offen lds
    s_mov_b64 exec, -1
    s_add_u32 m0, s59, 75904
    s_mov_b32 s96, 128
    buffer_load_dwordx4 v17, s[8:11], s96 offen lds
    s_add_u32 m0, s59, 80000
    s_mov_b32 s96, 28800
    buffer_load_dwordx4 v17, s[8:11], s96 offen lds
    s_add_u32 m0, s59, 84096
    s_mov_b32 s96, 57472
    buffer_load_dwordx4 v17, s[8:11], s96 offen lds
    s_add_u32 m0, s59, 88192
    s_mov_b32 s96, 86144
    buffer_load_dwordx4 v17, s[8:11], s96 offen lds
    s_add_u32 m0, s59, 92288
    s_mov_b32 s96, 114816
    buffer_load_dwordx4 v17, s[8:11], s96 offen lds
    s_add_u32 m0, s59, 96384
    s_mov_b32 s96, 143488
    buffer_load_dwordx4 v17, s[8:11], s96 offen lds
    s_mov_b32 s18, 401408
    s_mov_b32 s19, 0x00020000
    s_mov_b32 s22, 1605632
    s_mov_b32 s23, 0x00020000
    s_mov_b32 s26, 1605632
    s_mov_b32 s27, 0x00020000
    s_mov_b32 s30, 1605632
    s_mov_b32 s31, 0x00020000
    s_mov_b32 s34, 1835008
    s_mov_b32 s35, 0x00020000
    v_lshlrev_b32 v16, 4, v1
    v_cmp_eq_u32 s[68:69], 3, v3
    s_lshr_b32 s46, s4, 2
    s_cmp_ge_u32 s6, 16
    s_cselect_b32 s60, 2, 0
    s_sub_u32 s49, s6, s60
    s_mul_i32 s51, s49, 37
    s_lshr_b32 s51, s51, 8
    s_mul_i32 s60, s51, 7
    s_sub_u32 s52, s49, s60
    s_lshl_b32 s58, s4, 10
    v_lshlrev_b32 v5, 1, v3
    v_and_b32 v6, 7, v1
    v_xor_b32 v5, v5, v6
    v_lshrrev_b32 v4, 3, v1
    v_mul_u32_u24 v7, 3584, v4
    v_lshl_add_u32 v7, v5, 4, v7
    s_mul_i32 s60, s4, 28672
    s_lshl_b32 s61, s49, 7
    s_add_u32 s60, s60, s61
    v_add_u32 v28, s60, v7
    v_xor_b32 v29, 64, v28
    s_lshl_b32 s60, s5, 3
    s_add_u32 s60, s60, s4
    s_mul_i32 s61, s60, 112
    s_add_u32 s61, s61, s48
    s_lshl_b32 s61, s61, 10
    s_add_u32 s84, s61, 2097152
    s_add_u32 s87, s84, 57344
    s_lshl_b32 s60, s4, 4
    s_waitcnt vmcnt(7) lgkmcnt(0)
    s_barrier
    ds_read_b128 v[188:191], v146 offset:0
    ds_read_b64_tr_b16 v[176:177], v20 offset:0
    ds_read_b64_tr_b16 v[178:179], v20 offset:256
    ds_read_b128 v[192:195], v146 offset:2048
    ds_read_b128 v[196:199], v147 offset:0
    ds_read_b128 v[200:203], v147 offset:2048
    ds_read_b128 v[204:207], v158
    ds_read_b64_tr_b16 v[180:181], v21 offset:0
    ds_read_b64_tr_b16 v[182:183], v21 offset:256
    ds_read_b64_tr_b16 v[184:185], v22 offset:0
    ds_read_b64_tr_b16 v[186:187], v22 offset:256
    s_waitcnt lgkmcnt(10)
    v_mfma_f32_16x16x32_bf16 v[80:83], v[188:191], v[188:191], 0
    ds_read_b128 v[220:223], v148 offset:0
    s_add_u32 s60, s60, s48
    s_waitcnt lgkmcnt(9)
    v_mfma_f32_16x16x32_bf16 v[32:35], v[176:179], v[188:191], 0
    ds_read_b64_tr_b16 v[208:209], v20 offset:6656
    s_lshl_b32 s60, s60, 2
    s_waitcnt lgkmcnt(9)
    v_mfma_f32_16x16x32_bf16 v[84:87], v[192:195], v[192:195], 0
    ds_read_b64_tr_b16 v[210:211], v20 offset:6912
    s_add_u32 m0, s59, 143616
    s_movk_i32 s96, 256
    s_cmp_lt_u32 s4, 2
    s_cselect_b64 exec, -1, 0
    buffer_load_dwordx4 v19, s[8:11], s96 offen lds
    s_mov_b64 exec, -1
    s_add_u32 s60, s60, s54
    s_nop 4
    v_mfma_f32_16x16x32_bf16 v[44:47], v[176:179], v[192:195], 0
    ds_read_b128 v[224:227], v148 offset:2048
    s_add_u32 s85, s60, 1024
    s_waitcnt lgkmcnt(10)
    v_mfma_f32_16x16x32_bf16 v[56:59], v[176:179], v[196:199], 0
    s_add_u32 m0, s59, 110848
    s_mov_b32 s96, 256
    buffer_load_dwordx4 v17, s[8:11], s96 offen lds
    s_mul_i32 s88, s94, 1280
    s_waitcnt lgkmcnt(9)
    v_mfma_f32_16x16x32_bf16 v[68:71], v[176:179], v[200:203], 0
    ds_read_b128 v[228:231], v149 offset:0
    s_mul_i32 s89, s95, 1280
    s_waitcnt lgkmcnt(9)
    v_mfma_f32_16x16x32_bf16 v[88:91], v[176:179], v[204:207], 0
    ds_read_b128 v[232:235], v149 offset:2048
    s_add_u32 m0, s59, 114944
    s_mov_b32 s96, 28928
    buffer_load_dwordx4 v17, s[8:11], s96 offen lds
    v_mul_u32_u24 v10, 80, v2
    s_waitcnt lgkmcnt(8)
    v_mfma_f32_16x16x32_bf16 v[36:39], v[180:183], v[188:191], 0
    ds_read_b128 v[236:239], v159
    v_lshl_add_u32 v9, v3, 4, v10
    v_mfma_f32_16x16x32_bf16 v[48:51], v[180:183], v[192:195], 0
    ds_read_b64_tr_b16 v[212:213], v21 offset:6656
    v_lshl_add_u32 v10, v3, 3, v10
    v_mfma_f32_16x16x32_bf16 v[60:63], v[180:183], v[196:199], 0
    s_add_u32 m0, s59, 119040
    s_mov_b32 s96, 57600
    buffer_load_dwordx4 v17, s[8:11], s96 offen lds
    v_add_u32 v122, s88, v9
    v_mfma_f32_16x16x32_bf16 v[72:75], v[180:183], v[200:203], 0
    ds_read_b64_tr_b16 v[214:215], v21 offset:6912
    v_bfe_u32 v6, v1, 2, 2
    v_mfma_f32_16x16x32_bf16 v[92:95], v[180:183], v[204:207], 0
    ds_read_b64_tr_b16 v[216:217], v22 offset:6656
    s_add_u32 m0, s59, 123136
    s_mov_b32 s96, 86272
    buffer_load_dwordx4 v17, s[8:11], s96 offen lds
    v_lshl_add_u32 v6, v3, 2, v6
    s_waitcnt lgkmcnt(10)
    v_mfma_f32_16x16x32_bf16 v[40:43], v[184:187], v[188:191], 0
    ds_read_b64_tr_b16 v[218:219], v22 offset:6912
    v_mul_u32_u24 v6, 80, v6
    v_mfma_f32_16x16x32_bf16 v[52:55], v[184:187], v[192:195], 0
    s_add_u32 m0, s59, 127232
    s_mov_b32 s96, 114944
    buffer_load_dwordx4 v17, s[8:11], s96 offen lds
    v_and_b32 v7, 3, v1
    v_mfma_f32_16x16x32_bf16 v[64:67], v[184:187], v[196:199], 0
    v_lshl_add_u32 v6, v7, 3, v6
    v_mfma_f32_16x16x32_bf16 v[76:79], v[184:187], v[200:203], 0
    s_add_u32 m0, s59, 131328
    s_mov_b32 s96, 143616
    buffer_load_dwordx4 v17, s[8:11], s96 offen lds
    v_add_u32 v123, s88, v6
    s_waitcnt vmcnt(6) lgkmcnt(0)
    s_barrier
    v_readfirstlane_b32 s55, v14
    s_nop 0
    s_add_u32 s53, s55, 1
    s_mul_i32 s53, s53, 0x9E3779B1
    s_xor_b32 s53, s53, 0x5bd1e995
    s_and_b32 s96, s53, 0xfffffff0
    s_or_b32 s96, s96, s101
    v_mov_b32 v125, s96
    s_lshl_b64 exec, 1, s6
    s_cmp_eq_u32 s4, 0
    s_cselect_b64 exec, exec, 0
    buffer_store_dword v125, v124, s[36:39], s54 offen sc1
    s_mov_b64 exec, -1
    s_nop 5
    v_mfma_f32_16x16x32_bf16 v[80:83], v[220:223], v[220:223], v[80:83]
    ds_read_b128 v[188:191], v150 offset:0
    s_lshr_b32 s60, s63, 1
    v_mfma_f32_16x16x32_bf16 v[32:35], v[208:211], v[220:223], v[32:35]
    ds_read_b64_tr_b16 v[176:177], v20 offset:13312
    s_mul_i32 s60, s60, 21760
    v_mfma_f32_16x16x32_bf16 v[84:87], v[224:227], v[224:227], v[84:87]
    ds_read_b64_tr_b16 v[178:179], v20 offset:13568
    s_and_b32 s61, s63, 1
    v_mfma_f32_16x16x32_bf16 v[44:47], v[208:211], v[224:227], v[44:47]
    ds_read_b128 v[192:195], v150 offset:2048
    s_add_u32 m0, s59, 73728
    s_movk_i32 s96, 384
    s_cmp_lt_u32 s4, 2
    s_cselect_b64 exec, -1, 0
    buffer_load_dwordx4 v19, s[8:11], s96 offen lds
    s_mov_b64 exec, -1
    s_lshl_b32 s61, s61, 5
    s_nop 4
    v_mfma_f32_16x16x32_bf16 v[56:59], v[208:211], v[228:231], v[56:59]
    s_add_u32 s60, s60, s61
    v_mfma_f32_16x16x32_bf16 v[68:71], v[208:211], v[232:235], v[68:71]
    ds_read_b128 v[196:199], v151 offset:0
    v_add_u32 v11, s60, v10
    v_mfma_f32_16x16x32_bf16 v[88:91], v[208:211], v[236:239], v[88:91]
    ds_read_b128 v[200:203], v151 offset:2048
    v_add_u32 v114, s88, v11
    v_mfma_f32_16x16x32_bf16 v[36:39], v[212:215], v[220:223], v[36:39]
    ds_read_b128 v[204:207], v160
    s_add_u32 m0, s59, 40960
    s_mov_b32 s96, 384
    buffer_load_dwordx4 v17, s[8:11], s96 offen lds
    v_add_u32 v117, s89, v11
    v_mfma_f32_16x16x32_bf16 v[48:51], v[212:215], v[224:227], v[48:51]
    ds_read_b64_tr_b16 v[180:181], v21 offset:13312
    v_mov_b32 v120, v11
    v_mfma_f32_16x16x32_bf16 v[60:63], v[212:215], v[228:231], v[60:63]
    s_lshl_b32 s60, s63, 6
    v_mfma_f32_16x16x32_bf16 v[72:75], v[212:215], v[232:235], v[72:75]
    ds_read_b64_tr_b16 v[182:183], v21 offset:13568
    s_add_u32 s60, s60, 158720
    v_mfma_f32_16x16x32_bf16 v[92:95], v[212:215], v[236:239], v[92:95]
    ds_read_b64_tr_b16 v[184:185], v22 offset:13312
    s_add_u32 m0, s59, 45056
    s_mov_b32 s96, 29056
    buffer_load_dwordx4 v17, s[8:11], s96 offen lds
    v_lshl_add_u32 v111, v3, 4, s60
    v_mfma_f32_16x16x32_bf16 v[40:43], v[216:219], v[220:223], v[40:43]
    ds_read_b64_tr_b16 v[186:187], v22 offset:13568
    s_lshr_b32 s60, s64, 1
    v_mfma_f32_16x16x32_bf16 v[52:55], v[216:219], v[224:227], v[52:55]
    s_mul_i32 s60, s60, 21760
    v_mfma_f32_16x16x32_bf16 v[64:67], v[216:219], v[228:231], v[64:67]
    s_and_b32 s61, s64, 1
    v_mfma_f32_16x16x32_bf16 v[76:79], v[216:219], v[232:235], v[76:79]
    s_add_u32 m0, s59, 49152
    s_mov_b32 s96, 57728
    buffer_load_dwordx4 v17, s[8:11], s96 offen lds
    s_lshl_b32 s61, s61, 5
    s_waitcnt lgkmcnt(10)
    v_mfma_f32_16x16x32_bf16 v[80:83], v[188:191], v[188:191], v[80:83]
    ds_read_b128 v[220:223], v152 offset:0
    s_add_u32 s60, s60, s61
    s_waitcnt lgkmcnt(9)
    v_mfma_f32_16x16x32_bf16 v[32:35], v[176:179], v[188:191], v[32:35]
    ds_read_b64_tr_b16 v[208:209], v20 offset:19968
    v_add_u32 v11, s60, v10
    s_waitcnt lgkmcnt(9)
    v_mfma_f32_16x16x32_bf16 v[84:87], v[192:195], v[192:195], v[84:87]
    ds_read_b64_tr_b16 v[210:211], v20 offset:20224
    v_add_u32 v115, s88, v11
    v_mfma_f32_16x16x32_bf16 v[44:47], v[176:179], v[192:195], v[44:47]
    ds_read_b128 v[224:227], v152 offset:2048
    v_add_u32 v118, s89, v11
    s_waitcnt lgkmcnt(10)
    v_mfma_f32_16x16x32_bf16 v[56:59], v[176:179], v[196:199], v[56:59]
    v_mov_b32 v121, v11
    s_waitcnt lgkmcnt(9)
    v_mfma_f32_16x16x32_bf16 v[68:71], v[176:179], v[200:203], v[68:71]
    ds_read_b128 v[228:231], v153 offset:0
    s_add_u32 m0, s59, 53248
    s_mov_b32 s96, 86400
    buffer_load_dwordx4 v17, s[8:11], s96 offen lds
    s_lshl_b32 s60, s64, 6
    s_waitcnt lgkmcnt(9)
    v_mfma_f32_16x16x32_bf16 v[88:91], v[176:179], v[204:207], v[88:91]
    ds_read_b128 v[232:235], v153 offset:2048
    s_add_u32 s60, s60, 158720
    s_waitcnt lgkmcnt(8)
    v_mfma_f32_16x16x32_bf16 v[36:39], v[180:183], v[188:191], v[36:39]
    ds_read_b128 v[236:239], v161
    v_lshl_add_u32 v112, v3, 4, s60
    v_mfma_f32_16x16x32_bf16 v[48:51], v[180:183], v[192:195], v[48:51]
    ds_read_b64_tr_b16 v[212:213], v21 offset:19968
    s_lshr_b32 s60, s65, 1
    v_mfma_f32_16x16x32_bf16 v[60:63], v[180:183], v[196:199], v[60:63]
    s_mul_i32 s60, s60, 21760
    v_mfma_f32_16x16x32_bf16 v[72:75], v[180:183], v[200:203], v[72:75]
    ds_read_b64_tr_b16 v[214:215], v21 offset:20224
    s_add_u32 m0, s59, 57344
    s_mov_b32 s96, 115072
    buffer_load_dwordx4 v17, s[8:11], s96 offen lds
    s_and_b32 s61, s65, 1
    v_mfma_f32_16x16x32_bf16 v[92:95], v[180:183], v[204:207], v[92:95]
    ds_read_b64_tr_b16 v[216:217], v22 offset:19968
    s_lshl_b32 s61, s61, 5
    s_waitcnt lgkmcnt(10)
    v_mfma_f32_16x16x32_bf16 v[40:43], v[184:187], v[188:191], v[40:43]
    ds_read_b64_tr_b16 v[218:219], v22 offset:20224
    s_add_u32 s60, s60, s61
    v_mfma_f32_16x16x32_bf16 v[52:55], v[184:187], v[192:195], v[52:55]
    v_add_u32 v11, s60, v10
    v_mfma_f32_16x16x32_bf16 v[64:67], v[184:187], v[196:199], v[64:67]
    v_add_u32 v116, s88, v11
    v_mfma_f32_16x16x32_bf16 v[76:79], v[184:187], v[200:203], v[76:79]
    s_add_u32 m0, s59, 61440
    s_mov_b32 s96, 143744
    buffer_load_dwordx4 v17, s[8:11], s96 offen lds
    v_add_u32 v119, s89, v11
    s_waitcnt vmcnt(6) lgkmcnt(0)
    s_barrier
    v_mfma_f32_16x16x32_bf16 v[80:83], v[220:223], v[220:223], v[80:83]
    ds_read_b128 v[188:191], v154 offset:0
    s_lshl_b32 s60, s65, 6
    v_mfma_f32_16x16x32_bf16 v[32:35], v[208:211], v[220:223], v[32:35]
    ds_read_b64_tr_b16 v[176:177], v20 offset:26624
    s_add_u32 s60, s60, 158720
    v_mfma_f32_16x16x32_bf16 v[84:87], v[224:227], v[224:227], v[84:87]
    ds_read_b64_tr_b16 v[178:179], v20 offset:26880
    v_lshl_add_u32 v113, v3, 4, s60
    v_mfma_f32_16x16x32_bf16 v[44:47], v[208:211], v[224:227], v[44:47]
    ds_read_b128 v[192:195], v154 offset:2048
    s_add_u32 m0, s59, 108672
    s_movk_i32 s96, 512
    s_cmp_lt_u32 s4, 2
    s_cselect_b64 exec, -1, 0
    buffer_load_dwordx4 v19, s[8:11], s96 offen lds
    s_mov_b64 exec, -1
    v_lshlrev_b32 v110, 3, v2
    s_nop 4
    v_mfma_f32_16x16x32_bf16 v[56:59], v[208:211], v[228:231], v[56:59]
    v_add_u32 v110, 159744, v110
    v_mfma_f32_16x16x32_bf16 v[68:71], v[208:211], v[232:235], v[68:71]
    ds_read_b128 v[196:199], v155 offset:0
    s_lshl_b32 s60, s94, 7
    v_mfma_f32_16x16x32_bf16 v[88:91], v[208:211], v[236:239], v[88:91]
    ds_read_b128 v[200:203], v155 offset:2048
    v_add_u32 v108, s60, v110
    v_mfma_f32_16x16x32_bf16 v[36:39], v[212:215], v[220:223], v[36:39]
    ds_read_b128 v[204:207], v162
    s_add_u32 m0, s59, 75904
    s_mov_b32 s96, 512
    buffer_load_dwordx4 v17, s[8:11], s96 offen lds
    s_lshl_b32 s60, s95, 7
    v_mfma_f32_16x16x32_bf16 v[48:51], v[212:215], v[224:227], v[48:51]
    ds_read_b64_tr_b16 v[180:181], v21 offset:26624
    v_add_u32 v109, s60, v110
    v_mfma_f32_16x16x32_bf16 v[60:63], v[212:215], v[228:231], v[60:63]
    v_and_b32 v135, 1, v2
    v_mfma_f32_16x16x32_bf16 v[72:75], v[212:215], v[232:235], v[72:75]
    ds_read_b64_tr_b16 v[182:183], v21 offset:26880
    v_lshlrev_b32 v135, 4, v135
    v_mfma_f32_16x16x32_bf16 v[92:95], v[212:215], v[236:239], v[92:95]
    ds_read_b64_tr_b16 v[184:185], v22 offset:26624
    s_add_u32 m0, s59, 80000
    s_mov_b32 s96, 29184
    buffer_load_dwordx4 v17, s[8:11], s96 offen lds
    v_lshlrev_b32 v6, 2, v3
    v_mfma_f32_16x16x32_bf16 v[40:43], v[216:219], v[220:223], v[40:43]
    ds_read_b64_tr_b16 v[186:187], v22 offset:26880
    v_sub_u32 v6, v6, v2
    v_mfma_f32_16x16x32_bf16 v[52:55], v[216:219], v[224:227], v[52:55]
    v_mov_b32 v7, 0xf149f2ca
    v_mfma_f32_16x16x32_bf16 v[64:67], v[216:219], v[228:231], v[64:67]
    s_add_u32 s60, s50, s4
    v_mfma_f32_16x16x32_bf16 v[76:79], v[216:219], v[232:235], v[76:79]
    s_add_u32 m0, s59, 84096
    s_mov_b32 s96, 57856
    buffer_load_dwordx4 v17, s[8:11], s96 offen lds
    s_cmp_eq_u32 s60, 0
    s_cselect_b64 s[90:91], 0, -1
    s_waitcnt lgkmcnt(10)
    v_mfma_f32_16x16x32_bf16 v[80:83], v[188:191], v[188:191], v[80:83]
    ds_read_b128 v[220:223], v156 offset:0
    v_add_u32 v8, 0, v6
    s_waitcnt lgkmcnt(9)
    v_mfma_f32_16x16x32_bf16 v[32:35], v[176:179], v[188:191], v[32:35]
    ds_read_b64_tr_b16 v[208:209], v20 offset:33280
    v_and_b32 v9, 1, v8
    s_waitcnt lgkmcnt(9)
    v_mfma_f32_16x16x32_bf16 v[84:87], v[192:195], v[192:195], v[84:87]
    ds_read_b64_tr_b16 v[210:211], v20 offset:33536
    v_cmp_eq_u32 s[70:71], 0, v9
    v_mfma_f32_16x16x32_bf16 v[44:47], v[176:179], v[192:195], v[44:47]
    ds_read_b128 v[224:227], v156 offset:2048
    v_cmp_le_i32 s[72:73], 2, v8
    s_waitcnt lgkmcnt(10)
    v_mfma_f32_16x16x32_bf16 v[56:59], v[176:179], v[196:199], v[56:59]
    v_cmp_ge_i32 s[74:75], 0, v8
    s_waitcnt lgkmcnt(9)
    v_mfma_f32_16x16x32_bf16 v[68:71], v[176:179], v[200:203], v[68:71]
    ds_read_b128 v[228:231], v157 offset:0
    s_add_u32 m0, s59, 88192
    s_mov_b32 s96, 86528
    buffer_load_dwordx4 v17, s[8:11], s96 offen lds
    s_and_b64 s[72:73], s[72:73], s[70:71]
    s_waitcnt lgkmcnt(9)
    v_mfma_f32_16x16x32_bf16 v[88:91], v[176:179], v[204:207], v[88:91]
    ds_read_b128 v[232:235], v157 offset:2048
    s_and_b64 s[74:75], s[74:75], s[70:71]
    s_waitcnt lgkmcnt(8)
    v_mfma_f32_16x16x32_bf16 v[36:39], v[180:183], v[188:191], v[36:39]
    ds_read_b128 v[236:239], v163
    v_cndmask_b32 v100, v7, 0, s[72:73]
    v_mfma_f32_16x16x32_bf16 v[48:51], v[180:183], v[192:195], v[48:51]
    ds_read_b64_tr_b16 v[212:213], v21 offset:33280
    v_cndmask_b32 v104, v7, 0, s[74:75]
    v_mfma_f32_16x16x32_bf16 v[60:63], v[180:183], v[196:199], v[60:63]
    v_cndmask_b32 v96, v7, v100, s[90:91]
    v_mfma_f32_16x16x32_bf16 v[72:75], v[180:183], v[200:203], v[72:75]
    ds_read_b64_tr_b16 v[214:215], v21 offset:33536
    s_add_u32 m0, s59, 92288
    s_mov_b32 s96, 115200
    buffer_load_dwordx4 v17, s[8:11], s96 offen lds
    v_add_u32 v8, 1, v6
    v_mfma_f32_16x16x32_bf16 v[92:95], v[180:183], v[204:207], v[92:95]
    ds_read_b64_tr_b16 v[216:217], v22 offset:33280
    v_and_b32 v9, 1, v8
    s_waitcnt lgkmcnt(10)
    v_mfma_f32_16x16x32_bf16 v[40:43], v[184:187], v[188:191], v[40:43]
    ds_read_b64_tr_b16 v[218:219], v22 offset:33536
    v_cmp_eq_u32 s[70:71], 0, v9
    v_mfma_f32_16x16x32_bf16 v[52:55], v[184:187], v[192:195], v[52:55]
    v_cmp_le_i32 s[72:73], 2, v8
    v_mfma_f32_16x16x32_bf16 v[64:67], v[184:187], v[196:199], v[64:67]
    v_cmp_ge_i32 s[74:75], 0, v8
    v_mfma_f32_16x16x32_bf16 v[76:79], v[184:187], v[200:203], v[76:79]
    s_add_u32 m0, s59, 96384
    s_mov_b32 s96, 143872
    buffer_load_dwordx4 v17, s[8:11], s96 offen lds
    s_and_b64 s[72:73], s[72:73], s[70:71]
    s_waitcnt vmcnt(6) lgkmcnt(0)
    s_barrier
    v_mfma_f32_16x16x32_bf16 v[80:83], v[220:223], v[220:223], v[80:83]
    ds_read_b128 v[188:191], v146 offset:0
    s_and_b64 s[74:75], s[74:75], s[70:71]
    v_mfma_f32_16x16x32_bf16 v[32:35], v[208:211], v[220:223], v[32:35]
    ds_read_b64_tr_b16 v[176:177], v20 offset:0
    v_cndmask_b32 v101, v7, 0, s[72:73]
    v_mfma_f32_16x16x32_bf16 v[84:87], v[224:227], v[224:227], v[84:87]
    ds_read_b64_tr_b16 v[178:179], v20 offset:256
    v_cndmask_b32 v105, v7, 0, s[74:75]
    v_mfma_f32_16x16x32_bf16 v[44:47], v[208:211], v[224:227], v[44:47]
    ds_read_b128 v[192:195], v146 offset:2048
    s_add_u32 m0, s59, 143616
    s_movk_i32 s96, 640
    s_cmp_lt_u32 s4, 2
    s_cselect_b64 exec, -1, 0
    buffer_load_dwordx4 v19, s[8:11], s96 offen lds
    s_mov_b64 exec, -1
    v_cndmask_b32 v97, v7, v101, s[90:91]
    s_nop 4
    v_mfma_f32_16x16x32_bf16 v[56:59], v[208:211], v[228:231], v[56:59]
    v_add_u32 v8, 2, v6
    v_mfma_f32_16x16x32_bf16 v[68:71], v[208:211], v[232:235], v[68:71]
    ds_read_b128 v[196:199], v147 offset:0
    v_and_b32 v9, 1, v8
    v_mfma_f32_16x16x32_bf16 v[88:91], v[208:211], v[236:239], v[88:91]
    ds_read_b128 v[200:203], v147 offset:2048
    v_cmp_eq_u32 s[70:71], 0, v9
    v_mfma_f32_16x16x32_bf16 v[36:39], v[212:215], v[220:223], v[36:39]
    ds_read_b128 v[204:207], v158
    s_add_u32 m0, s59, 110848
    s_mov_b32 s96, 640
    buffer_load_dwordx4 v17, s[8:11], s96 offen lds
    v_cmp_le_i32 s[72:73], 2, v8
    v_mfma_f32_16x16x32_bf16 v[48:51], v[212:215], v[224:227], v[48:51]
    ds_read_b64_tr_b16 v[180:181], v21 offset:0
    v_cmp_ge_i32 s[74:75], 0, v8
    v_mfma_f32_16x16x32_bf16 v[60:63], v[212:215], v[228:231], v[60:63]
    s_and_b64 s[72:73], s[72:73], s[70:71]
    v_mfma_f32_16x16x32_bf16 v[72:75], v[212:215], v[232:235], v[72:75]
    ds_read_b64_tr_b16 v[182:183], v21 offset:256
    s_and_b64 s[74:75], s[74:75], s[70:71]
    v_mfma_f32_16x16x32_bf16 v[92:95], v[212:215], v[236:239], v[92:95]
    ds_read_b64_tr_b16 v[184:185], v22 offset:0
    s_add_u32 m0, s59, 114944
    s_mov_b32 s96, 29312
    buffer_load_dwordx4 v17, s[8:11], s96 offen lds
    v_cndmask_b32 v102, v7, 0, s[72:73]
    v_mfma_f32_16x16x32_bf16 v[40:43], v[216:219], v[220:223], v[40:43]
    ds_read_b64_tr_b16 v[186:187], v22 offset:256
    v_cndmask_b32 v106, v7, 0, s[74:75]
    v_mfma_f32_16x16x32_bf16 v[52:55], v[216:219], v[224:227], v[52:55]
    v_cndmask_b32 v98, v7, v102, s[90:91]
    v_mfma_f32_16x16x32_bf16 v[64:67], v[216:219], v[228:231], v[64:67]
    v_add_u32 v8, 3, v6
    v_mfma_f32_16x16x32_bf16 v[76:79], v[216:219], v[232:235], v[76:79]
    s_add_u32 m0, s59, 119040
    s_mov_b32 s96, 57984
    buffer_load_dwordx4 v17, s[8:11], s96 offen lds
    v_and_b32 v9, 1, v8
    s_waitcnt lgkmcnt(10)
    v_mfma_f32_16x16x32_bf16 v[80:83], v[188:191], v[188:191], v[80:83]
    ds_read_b128 v[220:223], v148 offset:0
    v_cmp_eq_u32 s[70:71], 0, v9
    s_waitcnt lgkmcnt(9)
    v_mfma_f32_16x16x32_bf16 v[32:35], v[176:179], v[188:191], v[32:35]
    ds_read_b64_tr_b16 v[208:209], v20 offset:6656
    v_cmp_le_i32 s[72:73], 2, v8
    s_waitcnt lgkmcnt(9)
    v_mfma_f32_16x16x32_bf16 v[84:87], v[192:195], v[192:195], v[84:87]
    ds_read_b64_tr_b16 v[210:211], v20 offset:6912
    v_cmp_ge_i32 s[74:75], 0, v8
    v_mfma_f32_16x16x32_bf16 v[44:47], v[176:179], v[192:195], v[44:47]
    ds_read_b128 v[224:227], v148 offset:2048
    s_and_b64 s[72:73], s[72:73], s[70:71]
    s_waitcnt lgkmcnt(10)
    v_mfma_f32_16x16x32_bf16 v[56:59], v[176:179], v[196:199], v[56:59]
    s_and_b64 s[74:75], s[74:75], s[70:71]
    s_waitcnt lgkmcnt(9)
    v_mfma_f32_16x16x32_bf16 v[68:71], v[176:179], v[200:203], v[68:71]
    ds_read_b128 v[228:231], v149 offset:0
    s_add_u32 m0, s59, 123136
    s_mov_b32 s96, 86656
    buffer_load_dwordx4 v17, s[8:11], s96 offen lds
    v_cndmask_b32 v103, v7, 0, s[72:73]
    s_waitcnt lgkmcnt(9)
    v_mfma_f32_16x16x32_bf16 v[88:91], v[176:179], v[204:207], v[88:91]
    ds_read_b128 v[232:235], v149 offset:2048
    v_cndmask_b32 v107, v7, 0, s[74:75]
    s_waitcnt lgkmcnt(8)
    v_mfma_f32_16x16x32_bf16 v[36:39], v[180:183], v[188:191], v[36:39]
    ds_read_b128 v[236:239], v159
    v_cndmask_b32 v99, v7, v103, s[90:91]
    v_mfma_f32_16x16x32_bf16 v[48:51], v[180:183], v[192:195], v[48:51]
    ds_read_b64_tr_b16 v[212:213], v21 offset:6656
    v_lshrrev_b32 v5, 2, v2
    v_mfma_f32_16x16x32_bf16 v[60:63], v[180:183], v[196:199], v[60:63]
    v_cmp_eq_u32 s[90:91], v5, v3
    v_mfma_f32_16x16x32_bf16 v[72:75], v[180:183], v[200:203], v[72:75]
    ds_read_b64_tr_b16 v[214:215], v21 offset:6912
    s_add_u32 m0, s59, 127232
    s_mov_b32 s96, 115328
    buffer_load_dwordx4 v17, s[8:11], s96 offen lds
    v_and_b32 v5, 3, v2
    v_mfma_f32_16x16x32_bf16 v[92:95], v[180:183], v[204:207], v[92:95]
    ds_read_b64_tr_b16 v[216:217], v22 offset:6656
    v_cmp_eq_u32 s[92:93], 0, v5
    s_waitcnt lgkmcnt(10)
    v_mfma_f32_16x16x32_bf16 v[40:43], v[184:187], v[188:191], v[40:43]
    ds_read_b64_tr_b16 v[218:219], v22 offset:6912
    v_cmp_eq_u32 s[70:71], 1, v5
    v_mfma_f32_16x16x32_bf16 v[52:55], v[184:187], v[192:195], v[52:55]
    v_cmp_eq_u32 s[72:73], 2, v5
    v_mfma_f32_16x16x32_bf16 v[64:67], v[184:187], v[196:199], v[64:67]
    v_cmp_eq_u32 s[74:75], 3, v5
    v_mfma_f32_16x16x32_bf16 v[76:79], v[184:187], v[200:203], v[76:79]
    s_add_u32 m0, s59, 131328
    s_mov_b32 s96, 144000
    buffer_load_dwordx4 v17, s[8:11], s96 offen lds
    s_and_b64 s[92:93], s[92:93], s[90:91]
    s_waitcnt vmcnt(6) lgkmcnt(0)
    s_barrier
    v_mfma_f32_16x16x32_bf16 v[80:83], v[220:223], v[220:223], v[80:83]
    ds_read_b128 v[188:191], v150 offset:0
    s_and_b64 s[70:71], s[70:71], s[90:91]
    v_mfma_f32_16x16x32_bf16 v[32:35], v[208:211], v[220:223], v[32:35]
    ds_read_b64_tr_b16 v[176:177], v20 offset:13312
    s_and_b64 s[72:73], s[72:73], s[90:91]
    v_mfma_f32_16x16x32_bf16 v[84:87], v[224:227], v[224:227], v[84:87]
    ds_read_b64_tr_b16 v[178:179], v20 offset:13568
    s_and_b64 s[74:75], s[74:75], s[90:91]
    v_mfma_f32_16x16x32_bf16 v[44:47], v[208:211], v[224:227], v[44:47]
    ds_read_b128 v[192:195], v150 offset:2048
    s_add_u32 m0, s59, 73728
    s_movk_i32 s96, 768
    s_cmp_lt_u32 s4, 2
    s_cselect_b64 exec, -1, 0
    buffer_load_dwordx4 v19, s[8:11], s96 offen lds
    s_mov_b64 exec, -1
    s_lshl_b32 s62, s45, 1
    s_nop 4
    v_mfma_f32_16x16x32_bf16 v[56:59], v[208:211], v[228:231], v[56:59]
    s_add_u32 s62, s62, 1
    v_mfma_f32_16x16x32_bf16 v[68:71], v[208:211], v[232:235], v[68:71]
    ds_read_b128 v[196:199], v151 offset:0
    s_cmp_eq_u32 s63, s62
    s_cselect_b64 s[88:89], s[68:69], 0
    v_mfma_f32_16x16x32_bf16 v[88:91], v[208:211], v[236:239], v[88:91]
    ds_read_b128 v[200:203], v151 offset:2048
    s_cmp_eq_u32 s64, s62
    s_cselect_b64 s[90:91], s[68:69], 0
    v_mfma_f32_16x16x32_bf16 v[36:39], v[212:215], v[220:223], v[36:39]
    ds_read_b128 v[204:207], v160
    s_add_u32 m0, s59, 40960
    s_mov_b32 s96, 768
    buffer_load_dwordx4 v17, s[8:11], s96 offen lds
    s_cmp_eq_u32 s65, s62
    s_cselect_b64 s[94:95], s[68:69], 0
    v_mfma_f32_16x16x32_bf16 v[48:51], v[212:215], v[224:227], v[48:51]
    ds_read_b64_tr_b16 v[180:181], v21 offset:13312
    s_mov_b32 s62, 0x3e8b97f6
    v_mfma_f32_16x16x32_bf16 v[60:63], v[212:215], v[228:231], v[60:63]
    v_mfma_f32_16x16x32_bf16 v[72:75], v[212:215], v[232:235], v[72:75]
    ds_read_b64_tr_b16 v[182:183], v21 offset:13568
    v_mfma_f32_16x16x32_bf16 v[92:95], v[212:215], v[236:239], v[92:95]
    ds_read_b64_tr_b16 v[184:185], v22 offset:13312
    s_add_u32 m0, s59, 45056
    s_mov_b32 s96, 29440
    buffer_load_dwordx4 v17, s[8:11], s96 offen lds
    v_mfma_f32_16x16x32_bf16 v[40:43], v[216:219], v[220:223], v[40:43]
    ds_read_b64_tr_b16 v[186:187], v22 offset:13568
    v_mfma_f32_16x16x32_bf16 v[52:55], v[216:219], v[224:227], v[52:55]
    v_mfma_f32_16x16x32_bf16 v[64:67], v[216:219], v[228:231], v[64:67]
    v_mfma_f32_16x16x32_bf16 v[76:79], v[216:219], v[232:235], v[76:79]
    s_add_u32 m0, s59, 49152
    s_mov_b32 s96, 58112
    buffer_load_dwordx4 v17, s[8:11], s96 offen lds
    s_waitcnt lgkmcnt(10)
    v_mfma_f32_16x16x32_bf16 v[80:83], v[188:191], v[188:191], v[80:83]
    ds_read_b128 v[220:223], v152 offset:0
    s_waitcnt lgkmcnt(9)
    v_mfma_f32_16x16x32_bf16 v[32:35], v[176:179], v[188:191], v[32:35]
    ds_read_b64_tr_b16 v[208:209], v20 offset:19968
    s_waitcnt lgkmcnt(9)
    v_mfma_f32_16x16x32_bf16 v[84:87], v[192:195], v[192:195], v[84:87]
    ds_read_b64_tr_b16 v[210:211], v20 offset:20224
    v_mfma_f32_16x16x32_bf16 v[44:47], v[176:179], v[192:195], v[44:47]
    ds_read_b128 v[224:227], v152 offset:2048
    s_add_u32 m0, s59, 53248
    s_mov_b32 s96, 86784
    buffer_load_dwordx4 v17, s[8:11], s96 offen lds
    s_waitcnt lgkmcnt(10)
    v_mfma_f32_16x16x32_bf16 v[56:59], v[176:179], v[196:199], v[56:59]
    s_waitcnt lgkmcnt(9)
    v_mfma_f32_16x16x32_bf16 v[68:71], v[176:179], v[200:203], v[68:71]
    ds_read_b128 v[228:231], v153 offset:0
    s_waitcnt lgkmcnt(9)
    v_mfma_f32_16x16x32_bf16 v[88:91], v[176:179], v[204:207], v[88:91]
    ds_read_b128 v[232:235], v153 offset:2048
    s_waitcnt lgkmcnt(8)
    v_mfma_f32_16x16x32_bf16 v[36:39], v[180:183], v[188:191], v[36:39]
    ds_read_b128 v[236:239], v161
    s_add_u32 m0, s59, 57344
    s_mov_b32 s96, 115456
    buffer_load_dwordx4 v17, s[8:11], s96 offen lds
    v_mfma_f32_16x16x32_bf16 v[48:51], v[180:183], v[192:195], v[48:51]
    ds_read_b64_tr_b16 v[212:213], v21 offset:19968
    v_mfma_f32_16x16x32_bf16 v[60:63], v[180:183], v[196:199], v[60:63]
    v_mfma_f32_16x16x32_bf16 v[72:75], v[180:183], v[200:203], v[72:75]
    ds_read_b64_tr_b16 v[214:215], v21 offset:20224
    v_mfma_f32_16x16x32_bf16 v[92:95], v[180:183], v[204:207], v[92:95]
    ds_read_b64_tr_b16 v[216:217], v22 offset:19968
    s_add_u32 m0, s59, 61440
    s_mov_b32 s96, 144128
    buffer_load_dwordx4 v17, s[8:11], s96 offen lds
    s_waitcnt lgkmcnt(10)
    v_mfma_f32_16x16x32_bf16 v[40:43], v[184:187], v[188:191], v[40:43]
    ds_read_b64_tr_b16 v[218:219], v22 offset:20224
    v_mfma_f32_16x16x32_bf16 v[52:55], v[184:187], v[192:195], v[52:55]
    v_mfma_f32_16x16x32_bf16 v[64:67], v[184:187], v[196:199], v[64:67]
    v_mfma_f32_16x16x32_bf16 v[76:79], v[184:187], v[200:203], v[76:79]
    v_lshrrev_b32 v134, 3, v1
    v_mul_u32_u24 v134, 56320, v134
    v_lshl_add_u32 v134, v1, 7, v134
    s_mov_b64 exec, 0xffff
    buffer_load_dword v31, v134, s[36:39], s84 offen sc1
    s_mov_b64 exec, -1
    s_waitcnt vmcnt(7) lgkmcnt(0)
    s_barrier
    s_nop 3
    v_mfma_f32_16x16x32_bf16 v[80:83], v[220:223], v[220:223], v[80:83]
    ds_read_b128 v[188:191], v154 offset:0
    v_mfma_f32_16x16x32_bf16 v[32:35], v[208:211], v[220:223], v[32:35]
    ds_read_b64_tr_b16 v[176:177], v20 offset:26624
    v_mfma_f32_16x16x32_bf16 v[84:87], v[224:227], v[224:227], v[84:87]
    ds_read_b64_tr_b16 v[178:179], v20 offset:26880
    v_mfma_f32_16x16x32_bf16 v[44:47], v[208:211], v[224:227], v[44:47]
    ds_read_b128 v[192:195], v154 offset:2048
    v_mfma_f32_16x16x32_bf16 v[56:59], v[208:211], v[228:231], v[56:59]
    v_mfma_f32_16x16x32_bf16 v[68:71], v[208:211], v[232:235], v[68:71]
    ds_read_b128 v[196:199], v155 offset:0
    s_mov_b64 exec, 0xffffffff
    buffer_load_dword v14, v124, s[36:39], s54 offen sc1
    s_mov_b64 exec, -1
    s_nop 5
    v_mfma_f32_16x16x32_bf16 v[88:91], v[208:211], v[236:239], v[88:91]
    ds_read_b128 v[200:203], v155 offset:2048
    v_mfma_f32_16x16x32_bf16 v[36:39], v[212:215], v[220:223], v[36:39]
    ds_read_b128 v[204:207], v162
    v_mfma_f32_16x16x32_bf16 v[48:51], v[212:215], v[224:227], v[48:51]
    ds_read_b64_tr_b16 v[180:181], v21 offset:26624
    v_mfma_f32_16x16x32_bf16 v[60:63], v[212:215], v[228:231], v[60:63]
    v_mfma_f32_16x16x32_bf16 v[72:75], v[212:215], v[232:235], v[72:75]
    ds_read_b64_tr_b16 v[182:183], v21 offset:26880
    s_add_u32 m0, s58, 75904
    s_mov_b32 s96, 0
    buffer_load_dwordx4 v29, s[24:27], s96 offen lds
    v_mfma_f32_16x16x32_bf16 v[92:95], v[212:215], v[236:239], v[92:95]
    ds_read_b64_tr_b16 v[184:185], v22 offset:26624
    v_mfma_f32_16x16x32_bf16 v[40:43], v[216:219], v[220:223], v[40:43]
    ds_read_b64_tr_b16 v[186:187], v22 offset:26880
    v_mfma_f32_16x16x32_bf16 v[52:55], v[216:219], v[224:227], v[52:55]
    v_mfma_f32_16x16x32_bf16 v[64:67], v[216:219], v[228:231], v[64:67]
    v_mfma_f32_16x16x32_bf16 v[76:79], v[216:219], v[232:235], v[76:79]
    s_add_u32 m0, s58, 84096
    s_mov_b32 s96, 229376
    buffer_load_dwordx4 v29, s[24:27], s96 offen lds
    s_waitcnt lgkmcnt(10)
    v_mfma_f32_16x16x32_bf16 v[80:83], v[188:191], v[188:191], v[80:83]
    ds_read_b128 v[220:223], v156 offset:0
    s_waitcnt lgkmcnt(9)
    v_mfma_f32_16x16x32_bf16 v[32:35], v[176:179], v[188:191], v[32:35]
    ds_read_b64_tr_b16 v[208:209], v20 offset:33280
    s_waitcnt lgkmcnt(9)
    v_mfma_f32_16x16x32_bf16 v[84:87], v[192:195], v[192:195], v[84:87]
    ds_read_b64_tr_b16 v[210:211], v20 offset:33536
    v_mfma_f32_16x16x32_bf16 v[44:47], v[176:179], v[192:195], v[44:47]
    ds_read_b128 v[224:227], v156 offset:2048
    s_waitcnt lgkmcnt(10)
    v_mfma_f32_16x16x32_bf16 v[56:59], v[176:179], v[196:199], v[56:59]
    s_waitcnt lgkmcnt(9)
    v_mfma_f32_16x16x32_bf16 v[68:71], v[176:179], v[200:203], v[68:71]
    ds_read_b128 v[228:231], v157 offset:0
    s_waitcnt lgkmcnt(9)
    v_mfma_f32_16x16x32_bf16 v[88:91], v[176:179], v[204:207], v[88:91]
    ds_read_b128 v[232:235], v157 offset:2048
    s_waitcnt lgkmcnt(8)
    v_mfma_f32_16x16x32_bf16 v[36:39], v[180:183], v[188:191], v[36:39]
    ds_read_b128 v[236:239], v163
    s_add_u32 m0, s58, 92288
    s_mov_b32 s96, 458752
    buffer_load_dwordx4 v29, s[24:27], s96 offen lds
    v_mfma_f32_16x16x32_bf16 v[48:51], v[180:183], v[192:195], v[48:51]
    ds_read_b64_tr_b16 v[212:213], v21 offset:33280
    v_mfma_f32_16x16x32_bf16 v[60:63], v[180:183], v[196:199], v[60:63]
    v_mfma_f32_16x16x32_bf16 v[72:75], v[180:183], v[200:203], v[72:75]
    ds_read_b64_tr_b16 v[214:215], v21 offset:33536
    v_mfma_f32_16x16x32_bf16 v[92:95], v[180:183], v[204:207], v[92:95]
    ds_read_b64_tr_b16 v[216:217], v22 offset:33280
    s_waitcnt lgkmcnt(10)
    v_mfma_f32_16x16x32_bf16 v[40:43], v[184:187], v[188:191], v[40:43]
    ds_read_b64_tr_b16 v[218:219], v22 offset:33536
    v_mfma_f32_16x16x32_bf16 v[52:55], v[184:187], v[192:195], v[52:55]
    v_mfma_f32_16x16x32_bf16 v[64:67], v[184:187], v[196:199], v[64:67]
    v_mfma_f32_16x16x32_bf16 v[76:79], v[184:187], v[200:203], v[76:79]
    s_add_u32 m0, s58, 100480
    s_mov_b32 s96, 688128
    buffer_load_dwordx4 v29, s[24:27], s96 offen lds
    s_waitcnt vmcnt(6) lgkmcnt(0)
    s_barrier
    v_mfma_f32_16x16x32_bf16 v[80:83], v[220:223], v[220:223], v[80:83]
    ds_read_b128 v[188:191], v146 offset:0
    v_mfma_f32_16x16x32_bf16 v[32:35], v[208:211], v[220:223], v[32:35]
    ds_read_b64_tr_b16 v[176:177], v20 offset:0
    v_mfma_f32_16x16x32_bf16 v[84:87], v[224:227], v[224:227], v[84:87]
    ds_read_b64_tr_b16 v[178:179], v20 offset:256
    v_mfma_f32_16x16x32_bf16 v[44:47], v[208:211], v[224:227], v[44:47]
    ds_read_b128 v[192:195], v146 offset:2048
    v_mfma_f32_16x16x32_bf16 v[56:59], v[208:211], v[228:231], v[56:59]
    v_mfma_f32_16x16x32_bf16 v[68:71], v[208:211], v[232:235], v[68:71]
    ds_read_b128 v[196:199], v147 offset:0
    s_add_u32 m0, s58, 108672
    s_mov_b32 s96, 917504
    buffer_load_dwordx4 v29, s[24:27], s96 offen lds
    v_mfma_f32_16x16x32_bf16 v[88:91], v[208:211], v[236:239], v[88:91]
    ds_read_b128 v[200:203], v147 offset:2048
    v_mfma_f32_16x16x32_bf16 v[36:39], v[212:215], v[220:223], v[36:39]
    ds_read_b128 v[204:207], v158
    v_mfma_f32_16x16x32_bf16 v[48:51], v[212:215], v[224:227], v[48:51]
    ds_read_b64_tr_b16 v[180:181], v21 offset:0
    v_mfma_f32_16x16x32_bf16 v[60:63], v[212:215], v[228:231], v[60:63]
    v_mfma_f32_16x16x32_bf16 v[72:75], v[212:215], v[232:235], v[72:75]
    ds_read_b64_tr_b16 v[182:183], v21 offset:256
    s_add_u32 m0, s58, 116864
    s_mov_b32 s96, 1146880
    buffer_load_dwordx4 v29, s[24:27], s96 offen lds
    v_mfma_f32_16x16x32_bf16 v[92:95], v[212:215], v[236:239], v[92:95]
    ds_read_b64_tr_b16 v[184:185], v22 offset:0
    v_mfma_f32_16x16x32_bf16 v[40:43], v[216:219], v[220:223], v[40:43]
    ds_read_b64_tr_b16 v[186:187], v22 offset:256
    v_mfma_f32_16x16x32_bf16 v[52:55], v[216:219], v[224:227], v[52:55]
    v_mfma_f32_16x16x32_bf16 v[64:67], v[216:219], v[228:231], v[64:67]
    v_mfma_f32_16x16x32_bf16 v[76:79], v[216:219], v[232:235], v[76:79]
    s_add_u32 m0, s58, 125056
    s_mov_b32 s96, 1376256
    buffer_load_dwordx4 v29, s[24:27], s96 offen lds
    s_waitcnt lgkmcnt(10)
    v_mfma_f32_16x16x32_bf16 v[80:83], v[188:191], v[188:191], v[80:83]
    ds_read_b128 v[220:223], v148 offset:0
    ds_read_b64_tr_b16 v[208:209], v20 offset:6656
    s_waitcnt lgkmcnt(10)
    v_mfma_f32_16x16x32_bf16 v[32:35], v[176:179], v[188:191], v[32:35]
    ds_read_b64_tr_b16 v[210:211], v20 offset:6912
    s_waitcnt lgkmcnt(10)
    v_mfma_f32_16x16x32_bf16 v[84:87], v[192:195], v[192:195], v[84:87]
    ds_read_b128 v[224:227], v148 offset:2048
    ds_read_b128 v[228:231], v149 offset:0
    v_mfma_f32_16x16x32_bf16 v[44:47], v[176:179], v[192:195], v[44:47]
    ds_read_b128 v[232:235], v149 offset:2048
    s_waitcnt lgkmcnt(10)
    v_mfma_f32_16x16x32_bf16 v[88:91], v[176:179], v[204:207], v[88:91]
    ds_read_b128 v[236:239], v159
    s_waitcnt lgkmcnt(9)
    v_mfma_f32_16x16x32_bf16 v[36:39], v[180:183], v[188:191], v[36:39]
    ds_read_b64_tr_b16 v[212:213], v21 offset:6656
    ds_read_b64_tr_b16 v[214:215], v21 offset:6912
    v_mfma_f32_16x16x32_bf16 v[48:51], v[180:183], v[192:195], v[48:51]
    ds_read_b64_tr_b16 v[216:217], v22 offset:6656
    v_mfma_f32_16x16x32_bf16 v[92:95], v[180:183], v[204:207], v[92:95]
    ds_read_b64_tr_b16 v[218:219], v22 offset:6912
    s_waitcnt lgkmcnt(11)
    v_mfma_f32_16x16x32_bf16 v[40:43], v[184:187], v[188:191], v[40:43]
    v_mfma_f32_16x16x32_bf16 v[52:55], v[184:187], v[192:195], v[52:55]
    v_mfma_f32_16x16x32_bf16 v[56:59], v[176:179], v[196:199], v[56:59]
    v_mfma_f32_16x16x32_bf16 v[68:71], v[176:179], v[200:203], v[68:71]
    v_mfma_f32_16x16x32_bf16 v[60:63], v[180:183], v[196:199], v[60:63]
    s_waitcnt lgkmcnt(0)
    v_mfma_f32_16x16x32_bf16 v[80:83], v[220:223], v[220:223], v[80:83]
    v_mfma_f32_16x16x32_bf16 v[32:35], v[208:211], v[220:223], v[32:35]
    v_mfma_f32_16x16x32_bf16 v[84:87], v[224:227], v[224:227], v[84:87]
    v_mfma_f32_16x16x32_bf16 v[44:47], v[208:211], v[224:227], v[44:47]
    v_mfma_f32_16x16x32_bf16 v[88:91], v[208:211], v[236:239], v[88:91]
    v_mfma_f32_16x16x32_bf16 v[36:39], v[212:215], v[220:223], v[36:39]
    v_mfma_f32_16x16x32_bf16 v[48:51], v[212:215], v[224:227], v[48:51]
    v_mfma_f32_16x16x32_bf16 v[92:95], v[212:215], v[236:239], v[92:95]
    v_mfma_f32_16x16x32_bf16 v[40:43], v[216:219], v[220:223], v[40:43]
    v_mfma_f32_16x16x32_bf16 v[52:55], v[216:219], v[224:227], v[52:55]
    v_mfma_f32_16x16x32_bf16 v[72:75], v[180:183], v[200:203], v[72:75]
    v_mfma_f32_16x16x32_bf16 v[64:67], v[184:187], v[196:199], v[64:67]
    v_cndmask_b32 v241, 0, v80, s[92:93]
    v_cndmask_b32 v243, 0, v84, s[92:93]
    v_add_f32 v126, v32, v33
    v_add_f32 v130, v44, v45
    v_cndmask_b32 v241, v241, v81, s[70:71]
    v_cndmask_b32 v243, v243, v85, s[70:71]
    v_add_f32 v127, v36, v37
    v_add_f32 v131, v48, v49
    v_cndmask_b32 v241, v241, v82, s[72:73]
    v_cndmask_b32 v243, v243, v86, s[72:73]
    v_mfma_f32_16x16x32_bf16 v[76:79], v[184:187], v[200:203], v[76:79]
    v_add_f32 v128, v40, v41
    v_add_f32 v132, v52, v53
    v_cndmask_b32 v241, v241, v83, s[74:75]
    v_cndmask_b32 v243, v243, v87, s[74:75]
    v_cndmask_b32 v240, 0, v126, s[88:89]
    v_cndmask_b32 v242, 0, v130, s[88:89]
    v_mov_b32 v8, v241
    v_mov_b32 v9, v243
    v_cndmask_b32 v240, v240, v127, s[90:91]
    v_cndmask_b32 v242, v242, v131, s[90:91]
    v_mfma_f32_16x16x32_bf16 v[56:59], v[208:211], v[228:231], v[56:59]
    v_permlane32_swap_b32 v241, v8
    v_permlane32_swap_b32 v243, v9
    v_cndmask_b32 v240, v240, v128, s[94:95]
    v_cndmask_b32 v242, v242, v132, s[94:95]
    v_add_f32 v241, v241, v8
    v_add_f32 v243, v243, v9
    v_mov_b32 v6, v240
    v_mov_b32 v7, v242
    v_mov_b32 v8, v241
    v_mov_b32 v9, v243
    v_mfma_f32_16x16x32_bf16 v[68:71], v[208:211], v[232:235], v[68:71]
    v_permlane32_swap_b32 v240, v6
    v_permlane32_swap_b32 v242, v7
    v_permlane16_swap_b32 v241, v8
    v_permlane16_swap_b32 v243, v9
    v_add_f32 v240, v240, v6
    v_add_f32 v242, v242, v7
    v_add_f32 v241, v241, v8
    v_add_f32 v243, v243, v9
    v_mov_b32 v6, v240
    v_mov_b32 v7, v242
    v_mfma_f32_16x16x32_bf16 v[60:63], v[212:215], v[228:231], v[60:63]
    v_permlane16_swap_b32 v240, v6
    v_permlane16_swap_b32 v242, v7
    v_add_f32 v240, v240, v6
    v_add_f32 v242, v242, v7
    v_mul_f32 v240, 0x3b124925, v240
    v_mul_f32 v242, 0x3b124925, v242
    v_mul_f32 v241, 0x3b124925, v241
    v_mul_f32 v243, 0x3b124925, v243
    v_fma_f32 v241, -v240, v240, v241
    v_fma_f32 v243, -v242, v242, v243
    v_mfma_f32_16x16x32_bf16 v[72:75], v[212:215], v[232:235], v[72:75]
    v_max_f32 v241, 0, v241
    v_max_f32 v243, 0, v243
    v_cvt_pk_bf16_f32 v241, v241, v241
    v_cvt_pk_bf16_f32 v243, v243, v243
    v_lshlrev_b32 v241, 16, v241
    v_lshlrev_b32 v243, 16, v243
    v_add_f32 v241, 0x3727c5ac, v241
    v_add_f32 v243, 0x3727c5ac, v243
    v_cvt_pk_bf16_f32 v241, v241, v241
    v_cvt_pk_bf16_f32 v243, v243, v243
    v_mfma_f32_16x16x32_bf16 v[64:67], v[216:219], v[228:231], v[64:67]
    v_lshlrev_b32 v241, 16, v241
    v_lshlrev_b32 v243, 16, v243
    v_sqrt_f32 v241, v241
    v_sqrt_f32 v243, v243
    v_cvt_pk_bf16_f32 v240, v240, v240
    v_cvt_pk_bf16_f32 v242, v242, v242
    v_lshlrev_b32 v240, 16, v240
    v_lshlrev_b32 v242, 16, v242
    v_cvt_pk_bf16_f32 v241, v241, v241
    v_cvt_pk_bf16_f32 v243, v243, v243
    v_mfma_f32_16x16x32_bf16 v[76:79], v[216:219], v[232:235], v[76:79]
    v_lshlrev_b32 v241, 16, v241
    v_lshlrev_b32 v243, 16, v243
    v_rcp_f32 v241, v241
    v_rcp_f32 v243, v243
    v_mul_f32_e64 v240, -v240, v241
    v_mul_f32_e64 v242, -v242, v243
    s_mov_b64 exec, s[66:67]
    ds_write_b128 v111, v[88:91]
    ds_write_b128 v112, v[92:95]
    s_mov_b64 exec, 0xffff
    ds_write_b64 v108, v[240:241] offset:128
    ds_write_b64 v108, v[242:243] offset:256
    s_mov_b64 exec, -1
    s_waitcnt lgkmcnt(0)
    s_barrier
    ds_read_b128 v[176:179], v111
    ds_read_b128 v[180:183], v112
    ds_read_b128 v[184:187], v113
    ds_read_b64 v[244:245], v109 offset:128
    ds_read_b64 v[246:247], v109 offset:256
    ds_read_b64 v[248:249], v110
    v_mul_f32 v32, v241, v32
    v_mul_f32 v33, v241, v33
    v_mul_f32 v34, v241, v34
    v_mul_f32 v35, v241, v35
    v_mul_f32 v36, v241, v36
    v_mul_f32 v37, v241, v37
    v_mul_f32 v38, v241, v38
    v_mul_f32 v39, v241, v39
    v_mul_f32 v40, v241, v40
    v_mul_f32 v41, v241, v41
    v_mul_f32 v42, v241, v42
    v_mul_f32 v43, v241, v43
    v_mul_f32 v44, v243, v44
    v_mul_f32 v45, v243, v45
    v_mul_f32 v46, v243, v46
    v_mul_f32 v47, v243, v47
    v_mul_f32 v48, v243, v48
    v_mul_f32 v49, v243, v49
    v_mul_f32 v50, v243, v50
    v_mul_f32 v51, v243, v51
    v_mul_f32 v52, v243, v52
    v_mul_f32 v53, v243, v53
    v_mul_f32 v54, v243, v54
    v_mul_f32 v55, v243, v55
    s_waitcnt lgkmcnt(0)
    v_fmac_f32 v32, v240, v176
    v_fmac_f32 v33, v240, v177
    v_fmac_f32 v34, v240, v178
    v_fmac_f32 v35, v240, v179
    v_cvt_pk_bf16_f32 v200, v32, v33
    v_cvt_pk_bf16_f32 v201, v34, v35
    ds_write_b64 v114, v[200:201] offset:1280
    v_fmac_f32 v36, v240, v180
    v_fmac_f32 v37, v240, v181
    v_fmac_f32 v38, v240, v182
    v_fmac_f32 v39, v240, v183
    v_cvt_pk_bf16_f32 v202, v36, v37
    v_cvt_pk_bf16_f32 v203, v38, v39
    ds_write_b64 v115, v[202:203] offset:1280
    v_fmac_f32 v40, v240, v184
    v_fmac_f32 v41, v240, v185
    v_fmac_f32 v42, v240, v186
    v_fmac_f32 v43, v240, v187
    v_cvt_pk_bf16_f32 v204, v40, v41
    v_cvt_pk_bf16_f32 v205, v42, v43
    ds_write_b64 v116, v[204:205] offset:1280
    v_fmac_f32 v44, v242, v176
    v_fmac_f32 v45, v242, v177
    v_fmac_f32 v46, v242, v178
    v_fmac_f32 v47, v242, v179
    v_cvt_pk_bf16_f32 v206, v44, v45
    v_cvt_pk_bf16_f32 v207, v46, v47
    ds_write_b64 v114, v[206:207] offset:2560
    v_fmac_f32 v48, v242, v180
    v_fmac_f32 v49, v242, v181
    v_fmac_f32 v50, v242, v182
    v_fmac_f32 v51, v242, v183
    v_cvt_pk_bf16_f32 v208, v48, v49
    v_cvt_pk_bf16_f32 v209, v50, v51
    ds_write_b64 v115, v[208:209] offset:2560
    v_fmac_f32 v52, v242, v184
    v_fmac_f32 v53, v242, v185
    v_fmac_f32 v54, v242, v186
    v_fmac_f32 v55, v242, v187
    v_cvt_pk_bf16_f32 v210, v52, v53
    v_cvt_pk_bf16_f32 v211, v54, v55
    ds_write_b64 v116, v[210:211] offset:2560
    v_mul_f32 v56, v245, v56
    v_mul_f32 v57, v245, v57
    v_mul_f32 v58, v245, v58
    v_mul_f32 v59, v245, v59
    v_fmac_f32 v56, v244, v176
    v_fmac_f32 v57, v244, v177
    v_fmac_f32 v58, v244, v178
    v_fmac_f32 v59, v244, v179
    v_cvt_pk_bf16_f32 v212, v56, v57
    v_cvt_pk_bf16_f32 v213, v58, v59
    ds_write_b64 v117, v[212:213] offset:1280
    v_mul_f32 v60, v245, v60
    v_mul_f32 v61, v245, v61
    v_mul_f32 v62, v245, v62
    v_mul_f32 v63, v245, v63
    v_fmac_f32 v60, v244, v180
    v_fmac_f32 v61, v244, v181
    v_fmac_f32 v62, v244, v182
    v_fmac_f32 v63, v244, v183
    v_cvt_pk_bf16_f32 v214, v60, v61
    v_cvt_pk_bf16_f32 v215, v62, v63
    ds_write_b64 v118, v[214:215] offset:1280
    v_mul_f32 v64, v245, v64
    v_mul_f32 v65, v245, v65
    v_mul_f32 v66, v245, v66
    v_mul_f32 v67, v245, v67
    v_fmac_f32 v64, v244, v184
    v_fmac_f32 v65, v244, v185
    v_fmac_f32 v66, v244, v186
    v_fmac_f32 v67, v244, v187
    v_cvt_pk_bf16_f32 v216, v64, v65
    v_cvt_pk_bf16_f32 v217, v66, v67
    ds_write_b64 v119, v[216:217] offset:1280
    v_mul_f32 v68, v247, v68
    v_mul_f32 v69, v247, v69
    v_mul_f32 v70, v247, v70
    v_mul_f32 v71, v247, v71
    v_fmac_f32 v68, v246, v176
    v_fmac_f32 v69, v246, v177
    v_fmac_f32 v70, v246, v178
    v_fmac_f32 v71, v246, v179
    v_cvt_pk_bf16_f32 v218, v68, v69
    v_cvt_pk_bf16_f32 v219, v70, v71
    ds_write_b64 v117, v[218:219] offset:2560
    v_mul_f32 v72, v247, v72
    v_mul_f32 v73, v247, v73
    v_mul_f32 v74, v247, v74
    v_mul_f32 v75, v247, v75
    v_fmac_f32 v72, v246, v180
    v_fmac_f32 v73, v246, v181
    v_fmac_f32 v74, v246, v182
    v_fmac_f32 v75, v246, v183
    v_cvt_pk_bf16_f32 v220, v72, v73
    v_cvt_pk_bf16_f32 v221, v74, v75
    ds_write_b64 v118, v[220:221] offset:2560
    v_mul_f32 v76, v247, v76
    v_mul_f32 v77, v247, v77
    v_mul_f32 v78, v247, v78
    v_mul_f32 v79, v247, v79
    v_fmac_f32 v76, v246, v184
    v_fmac_f32 v77, v246, v185
    v_fmac_f32 v78, v246, v186
    v_fmac_f32 v79, v246, v187
    v_cvt_pk_bf16_f32 v222, v76, v77
    v_cvt_pk_bf16_f32 v223, v78, v79
    ds_write_b64 v119, v[222:223] offset:2560
    v_mul_f32 v88, v249, v88
    v_mul_f32 v89, v249, v89
    v_mul_f32 v90, v249, v90
    v_mul_f32 v91, v249, v91
    v_fmac_f32 v88, v248, v176
    v_fmac_f32 v89, v248, v177
    v_fmac_f32 v90, v248, v178
    v_fmac_f32 v91, v248, v179
    v_cvt_pk_bf16_f32 v224, v88, v89
    v_cvt_pk_bf16_f32 v225, v90, v91
    ds_write_b64 v120, v[224:225] offset:0
    v_mul_f32 v92, v249, v92
    v_mul_f32 v93, v249, v93
    v_mul_f32 v94, v249, v94
    v_mul_f32 v95, v249, v95
    v_fmac_f32 v92, v248, v180
    v_fmac_f32 v93, v248, v181
    v_fmac_f32 v94, v248, v182
    v_fmac_f32 v95, v248, v183
    v_cvt_pk_bf16_f32 v226, v92, v93
    v_cvt_pk_bf16_f32 v227, v94, v95
    ds_write_b64 v121, v[226:227] offset:0
    s_branch L_p1J_2
L_p1B_1:
    s_add_u32 m0, s57, 0
    s_mov_b32 s96, 0
    buffer_load_dwordx4 v18, s[12:15], s96 offen lds
    s_add_u32 m0, s59, 40960
    s_mov_b32 s96, 0
    buffer_load_dwordx4 v17, s[8:11], s96 offen lds
    s_add_u32 m0, s57, 2048
    s_mov_b32 s96, 896
    buffer_load_dwordx4 v18, s[12:15], s96 offen lds
    s_add_u32 m0, s59, 45056
    s_mov_b32 s96, 28672
    buffer_load_dwordx4 v17, s[8:11], s96 offen lds
    s_add_u32 m0, s57, 4096
    s_mov_b32 s96, 1792
    buffer_load_dwordx4 v18, s[12:15], s96 offen lds
    buffer_load_dword v14, v5, s[36:39], s54 offen sc1
    s_load_dwordx2 s[16:17], s[0:1], 16
    s_load_dwordx2 s[20:21], s[0:1], 32
    s_load_dwordx2 s[24:25], s[0:1], 40
    s_load_dwordx2 s[28:29], s[0:1], 48
    s_load_dwordx2 s[32:33], s[0:1], 56
    v_and_b32 v2, 15, v1
    s_lshr_b32 s44, s4, 1
    v_cmp_eq_u32 s[66:67], 0, v2
    v_bfe_u32 v4, v1, 2, 2
    v_lshl_add_u32 v4, v3, 3, v4
    v_lshlrev_b32 v4, 6, v4
    v_lshl_add_u32 v4, v9, 3, v4
    v_and_b32 v6, 1, v3
    v_lshl_add_u32 v7, v6, 5, v4
    v_cmp_eq_u32 s[70:71], 3, v9
    s_mul_i32 s62, s45, 3
    s_add_u32 s61, s44, 0
    s_cmp_ge_u32 s61, 3
    s_cselect_b32 s60, 3, 0
    s_sub_u32 s61, s61, s60
    s_add_u32 s63, s61, s62
    s_lshr_b32 s60, s63, 1
    s_lshl_b32 s90, s60, 3
    s_add_u32 s90, s90, 6144
    s_lshl_b32 s60, s60, 11
    s_and_b32 s61, s63, 1
    s_cselect_b64 vcc, s[70:71], 0
    s_lshl_b32 s61, s61, 5
    v_xor_b32 v11, s61, v7
    v_add_u32 v11, s60, v11
    v_mov_b32 v10, s90
    v_cndmask_b32 v20, v11, v10, vcc
    s_add_u32 s61, s44, 1
    s_cmp_ge_u32 s61, 3
    s_cselect_b32 s60, 3, 0
    s_sub_u32 s61, s61, s60
    s_add_u32 s64, s61, s62
    s_lshr_b32 s60, s64, 1
    s_lshl_b32 s90, s60, 3
    s_add_u32 s90, s90, 6144
    s_lshl_b32 s60, s60, 11
    s_and_b32 s61, s64, 1
    s_cselect_b64 vcc, s[70:71], 0
    s_lshl_b32 s61, s61, 5
    v_xor_b32 v11, s61, v7
    v_add_u32 v11, s60, v11
    v_mov_b32 v10, s90
    v_cndmask_b32 v21, v11, v10, vcc
    s_add_u32 s61, s44, 2
    s_cmp_ge_u32 s61, 3
    s_cselect_b32 s60, 3, 0
    s_sub_u32 s61, s61, s60
    s_add_u32 s65, s61, s62
    s_lshr_b32 s60, s65, 1
    s_lshl_b32 s90, s60, 3
    s_add_u32 s90, s90, 6144
    s_lshl_b32 s60, s60, 11
    s_and_b32 s61, s65, 1
    s_cselect_b64 vcc, s[70:71], 0
    s_lshl_b32 s61, s61, 5
    v_xor_b32 v11, s61, v7
    v_add_u32 v11, s60, v11
    v_mov_b32 v10, s90
    v_cndmask_b32 v22, v11, v10, vcc
    v_lshrrev_b32 v4, 1, v2
    v_xor_b32 v4, v4, v3
    v_lshlrev_b32 v4, 4, v4
    v_lshl_add_u32 v4, v2, 7, v4
    v_xor_b32 v5, 64, v4
    v_mov_b32 v10, 2048
    v_cndmask_b32 v6, v4, v10, s[66:67]
    v_cndmask_b32 v7, v5, v10, s[66:67]
    s_lshl_b32 s94, s4, 1
    s_xor_b32 s95, s94, 2
    s_lshl_b32 s60, s94, 11
    s_add_u32 s60, s60, 40960
    v_add_u32 v146, s60, v4
    v_add_u32 v148, s60, v5
    s_lshl_b32 s60, s95, 11
    s_add_u32 s60, s60, 40960
    v_add_u32 v147, s60, v4
    v_add_u32 v149, s60, v5
    v_add_u32 v158, 73728, v6
    v_add_u32 v159, 73728, v7
    s_lshl_b32 s60, s94, 11
    s_add_u32 s60, s60, 75904
    v_add_u32 v150, s60, v4
    v_add_u32 v152, s60, v5
    s_lshl_b32 s60, s95, 11
    s_add_u32 s60, s60, 75904
    v_add_u32 v151, s60, v4
    v_add_u32 v153, s60, v5
    v_add_u32 v160, 108672, v6
    v_add_u32 v161, 108672, v7
    s_lshl_b32 s60, s94, 11
    s_add_u32 s60, s60, 110848
    v_add_u32 v154, s60, v4
    v_add_u32 v156, s60, v5
    s_lshl_b32 s60, s95, 11
    s_add_u32 s60, s60, 110848
    v_add_u32 v155, s60, v4
    v_add_u32 v157, s60, v5
    v_add_u32 v162, 143616, v6
    v_add_u32 v163, 143616, v7
    v_lshrrev_b32 v4, 1, v1
    v_mul_u32_u24 v4, 6656, v4
    v_and_b32 v5, 1, v1
    v_lshl_add_u32 v4, v5, 8, v4
    v_mov_b32 v8, 0x3f80
    v_mov_b32 v9, 0
    v_mov_b32 v10, 0x3f800000
    v_mov_b32 v11, 0
    v_mov_b32 v6, 0
    v_mov_b32 v7, 0
    s_mov_b64 exec, 0xfff
    ds_write_b128 v4, v[8:11] offset:6144
    ds_write_b64 v4, v[6:7] offset:6160
    s_mov_b64 exec, 7
    v_mul_u32_u24 v4, 34944, v1
    v_add_u32 v4, 75776, v4
    v_mov_b32 v168, 0x3f803f80
    v_mov_b32 v169, 0x3f803f80
    v_mov_b32 v170, 0x3f803f80
    v_mov_b32 v171, 0x3f803f80
    ds_write_b128 v4, v[168:171]
    s_mov_b64 exec, -1
    s_getreg_b32 s101, hwreg(HW_REG_XCC_ID)
    s_and_b32 s101, s101, 15
    v_lshrrev_b32 v4, 3, v1
    v_lshlrev_b32 v4, 7, v4
    v_and_b32 v5, 7, v1
    v_lshl_add_u32 v124, v5, 2, v4
    v_add_u32 v124, 128, v124
    s_add_u32 m0, s57, 13312
    s_mov_b32 s96, 172032
    buffer_load_dwordx4 v18, s[12:15], s96 offen lds
    s_add_u32 m0, s59, 75904
    s_mov_b32 s96, 128
    buffer_load_dwordx4 v17, s[8:11], s96 offen lds
    s_add_u32 m0, s57, 15360
    s_mov_b32 s96, 172928
    buffer_load_dwordx4 v18, s[12:15], s96 offen lds
    s_add_u32 m0, s59, 80000
    s_mov_b32 s96, 28800
    buffer_load_dwordx4 v17, s[8:11], s96 offen lds
    s_add_u32 m0, s57, 17408
    s_mov_b32 s96, 173824
    buffer_load_dwordx4 v18, s[12:15], s96 offen lds
    s_mov_b32 s18, 401408
    s_mov_b32 s19, 0x00020000
    s_mov_b32 s22, 1605632
    s_mov_b32 s23, 0x00020000
    s_mov_b32 s26, 1605632
    s_mov_b32 s27, 0x00020000
    s_mov_b32 s30, 1605632
    s_mov_b32 s31, 0x00020000
    s_mov_b32 s34, 1835008
    s_mov_b32 s35, 0x00020000
    v_lshlrev_b32 v16, 4, v1
    v_cmp_eq_u32 s[68:69], 3, v3
    s_lshr_b32 s46, s4, 2
    s_cmp_ge_u32 s6, 16
    s_cselect_b32 s60, 2, 0
    s_sub_u32 s49, s6, s60
    s_mul_i32 s51, s49, 37
    s_lshr_b32 s51, s51, 8
    s_mul_i32 s60, s51, 7
    s_sub_u32 s52, s49, s60
    s_lshl_b32 s58, s4, 10
    v_lshlrev_b32 v5, 1, v3
    v_and_b32 v6, 7, v1
    v_xor_b32 v5, v5, v6
    v_lshrrev_b32 v4, 3, v1
    v_mul_u32_u24 v7, 3584, v4
    v_lshl_add_u32 v7, v5, 4, v7
    s_mul_i32 s60, s4, 28672
    s_lshl_b32 s61, s49, 7
    s_add_u32 s60, s60, s61
    v_add_u32 v28, s60, v7
    v_xor_b32 v29, 64, v28
    s_lshl_b32 s60, s5, 3
    s_add_u32 s60, s60, s4
    s_mul_i32 s61, s60, 112
    s_add_u32 s61, s61, s48
    s_lshl_b32 s61, s61, 10
    s_add_u32 s84, s61, 2097152
    s_add_u32 s87, s84, 57344
    s_lshl_b32 s60, s4, 4
    s_waitcnt vmcnt(6) lgkmcnt(0)
    s_barrier
    ds_read_b128 v[188:191], v146 offset:0
    ds_read_b64_tr_b16 v[176:177], v20 offset:0
    ds_read_b64_tr_b16 v[178:179], v20 offset:256
    ds_read_b128 v[192:195], v146 offset:2048
    ds_read_b128 v[196:199], v147 offset:0
    ds_read_b128 v[200:203], v147 offset:2048
    ds_read_b128 v[204:207], v158
    ds_read_b64_tr_b16 v[180:181], v21 offset:0
    ds_read_b64_tr_b16 v[182:183], v21 offset:256
    ds_read_b64_tr_b16 v[184:185], v22 offset:0
    ds_read_b64_tr_b16 v[186:187], v22 offset:256
    s_waitcnt lgkmcnt(10)
    v_mfma_f32_16x16x32_bf16 v[80:83], v[188:191], v[188:191], 0
    ds_read_b128 v[220:223], v148 offset:0
    s_add_u32 s60, s60, s48
    s_waitcnt lgkmcnt(9)
    v_mfma_f32_16x16x32_bf16 v[32:35], v[176:179], v[188:191], 0
    ds_read_b64_tr_b16 v[208:209], v20 offset:6656
    s_lshl_b32 s60, s60, 2
    s_waitcnt lgkmcnt(9)
    v_mfma_f32_16x16x32_bf16 v[84:87], v[192:195], v[192:195], 0
    ds_read_b64_tr_b16 v[210:211], v20 offset:6912
    s_add_u32 m0, s57, 26624
    s_mov_b32 s96, 344064
    buffer_load_dwordx4 v18, s[12:15], s96 offen lds
    s_add_u32 s60, s60, s54
    v_mfma_f32_16x16x32_bf16 v[44:47], v[176:179], v[192:195], 0
    ds_read_b128 v[224:227], v148 offset:2048
    s_add_u32 s85, s60, 1024
    s_waitcnt lgkmcnt(10)
    v_mfma_f32_16x16x32_bf16 v[56:59], v[176:179], v[196:199], 0
    ds_read_b128 v[228:231], v149 offset:0
    s_mul_i32 s88, s94, 1280
    s_waitcnt lgkmcnt(10)
    v_mfma_f32_16x16x32_bf16 v[68:71], v[176:179], v[200:203], 0
    ds_read_b128 v[232:235], v149 offset:2048
    s_add_u32 m0, s59, 110848
    s_mov_b32 s96, 256
    buffer_load_dwordx4 v17, s[8:11], s96 offen lds
    s_mul_i32 s89, s95, 1280
    s_waitcnt lgkmcnt(10)
    v_mfma_f32_16x16x32_bf16 v[88:91], v[204:207], v[204:207], 0
    v_mul_u32_u24 v10, 80, v2
    s_waitcnt lgkmcnt(8)
    v_mfma_f32_16x16x32_bf16 v[36:39], v[180:183], v[188:191], 0
    ds_read_b128 v[236:239], v159
    v_lshl_add_u32 v9, v3, 4, v10
    v_mfma_f32_16x16x32_bf16 v[48:51], v[180:183], v[192:195], 0
    ds_read_b64_tr_b16 v[212:213], v21 offset:6656
    s_add_u32 m0, s57, 28672
    s_mov_b32 s96, 344960
    buffer_load_dwordx4 v18, s[12:15], s96 offen lds
    v_lshl_add_u32 v10, v3, 3, v10
    v_mfma_f32_16x16x32_bf16 v[60:63], v[180:183], v[196:199], 0
    ds_read_b64_tr_b16 v[214:215], v21 offset:6912
    v_add_u32 v122, s88, v9
    v_mfma_f32_16x16x32_bf16 v[72:75], v[180:183], v[200:203], 0
    ds_read_b64_tr_b16 v[216:217], v22 offset:6656
    v_bfe_u32 v6, v1, 2, 2
    s_waitcnt lgkmcnt(10)
    v_mfma_f32_16x16x32_bf16 v[40:43], v[184:187], v[188:191], 0
    ds_read_b64_tr_b16 v[218:219], v22 offset:6912
    s_add_u32 m0, s59, 114944
    s_mov_b32 s96, 28928
    buffer_load_dwordx4 v17, s[8:11], s96 offen lds
    v_lshl_add_u32 v6, v3, 2, v6
    v_mfma_f32_16x16x32_bf16 v[52:55], v[184:187], v[192:195], 0
    v_mul_u32_u24 v6, 80, v6
    v_mfma_f32_16x16x32_bf16 v[64:67], v[184:187], v[196:199], 0
    v_and_b32 v7, 3, v1
    v_mfma_f32_16x16x32_bf16 v[76:79], v[184:187], v[200:203], 0
    s_add_u32 m0, s57, 30720
    s_mov_b32 s96, 345856
    buffer_load_dwordx4 v18, s[12:15], s96 offen lds
    v_lshl_add_u32 v6, v7, 3, v6
    s_waitcnt vmcnt(5) lgkmcnt(0)
    s_barrier
    v_readfirstlane_b32 s55, v14
    s_nop 0
    s_add_u32 s53, s55, 1
    s_mul_i32 s53, s53, 0x9E3779B1
    s_xor_b32 s53, s53, 0x5bd1e995
    v_mfma_f32_16x16x32_bf16 v[80:83], v[220:223], v[220:223], v[80:83]
    ds_read_b128 v[188:191], v150 offset:0
    v_add_u32 v123, s88, v6
    v_mfma_f32_16x16x32_bf16 v[32:35], v[208:211], v[220:223], v[32:35]
    ds_read_b64_tr_b16 v[176:177], v20 offset:13312
    s_lshr_b32 s60, s63, 1
    v_mfma_f32_16x16x32_bf16 v[84:87], v[224:227], v[224:227], v[84:87]
    ds_read_b64_tr_b16 v[178:179], v20 offset:13568
    s_mul_i32 s60, s60, 21760
    v_mfma_f32_16x16x32_bf16 v[44:47], v[208:211], v[224:227], v[44:47]
    ds_read_b128 v[192:195], v150 offset:2048
    s_and_b32 s61, s63, 1
    v_mfma_f32_16x16x32_bf16 v[56:59], v[208:211], v[228:231], v[56:59]
    ds_read_b128 v[196:199], v151 offset:0
    s_add_u32 m0, s57, 0
    s_mov_b32 s96, 516096
    buffer_load_dwordx4 v18, s[12:15], s96 offen lds
    s_lshl_b32 s61, s61, 5
    v_mfma_f32_16x16x32_bf16 v[68:71], v[208:211], v[232:235], v[68:71]
    ds_read_b128 v[200:203], v151 offset:2048
    s_add_u32 s60, s60, s61
    v_mfma_f32_16x16x32_bf16 v[88:91], v[236:239], v[236:239], v[88:91]
    v_add_u32 v11, s60, v10
    v_mfma_f32_16x16x32_bf16 v[36:39], v[212:215], v[220:223], v[36:39]
    ds_read_b128 v[204:207], v160
    v_add_u32 v114, s88, v11
    v_mfma_f32_16x16x32_bf16 v[48:51], v[212:215], v[224:227], v[48:51]
    ds_read_b64_tr_b16 v[180:181], v21 offset:13312
    v_add_u32 v117, s89, v11
    v_mfma_f32_16x16x32_bf16 v[60:63], v[212:215], v[228:231], v[60:63]
    ds_read_b64_tr_b16 v[182:183], v21 offset:13568
    s_add_u32 m0, s59, 40960
    s_mov_b32 s96, 384
    buffer_load_dwordx4 v17, s[8:11], s96 offen lds
    v_mov_b32 v120, v11
    v_mfma_f32_16x16x32_bf16 v[72:75], v[212:215], v[232:235], v[72:75]
    ds_read_b64_tr_b16 v[184:185], v22 offset:13312
    s_lshl_b32 s60, s63, 6
    v_mfma_f32_16x16x32_bf16 v[40:43], v[216:219], v[220:223], v[40:43]
    ds_read_b64_tr_b16 v[186:187], v22 offset:13568
    s_add_u32 s60, s60, 158720
    v_mfma_f32_16x16x32_bf16 v[52:55], v[216:219], v[224:227], v[52:55]
    v_lshl_add_u32 v111, v3, 4, s60
    v_mfma_f32_16x16x32_bf16 v[64:67], v[216:219], v[228:231], v[64:67]
    s_lshr_b32 s60, s64, 1
    v_mfma_f32_16x16x32_bf16 v[76:79], v[216:219], v[232:235], v[76:79]
    s_add_u32 m0, s57, 2048
    s_mov_b32 s96, 516992
    buffer_load_dwordx4 v18, s[12:15], s96 offen lds
    s_mul_i32 s60, s60, 21760
    s_waitcnt lgkmcnt(10)
    v_mfma_f32_16x16x32_bf16 v[80:83], v[188:191], v[188:191], v[80:83]
    ds_read_b128 v[220:223], v152 offset:0
    s_and_b32 s61, s64, 1
    s_waitcnt lgkmcnt(9)
    v_mfma_f32_16x16x32_bf16 v[32:35], v[176:179], v[188:191], v[32:35]
    ds_read_b64_tr_b16 v[208:209], v20 offset:19968
    s_lshl_b32 s61, s61, 5
    s_waitcnt lgkmcnt(9)
    v_mfma_f32_16x16x32_bf16 v[84:87], v[192:195], v[192:195], v[84:87]
    ds_read_b64_tr_b16 v[210:211], v20 offset:20224
    s_add_u32 s60, s60, s61
    v_mfma_f32_16x16x32_bf16 v[44:47], v[176:179], v[192:195], v[44:47]
    ds_read_b128 v[224:227], v152 offset:2048
    v_add_u32 v11, s60, v10
    s_waitcnt lgkmcnt(10)
    v_mfma_f32_16x16x32_bf16 v[56:59], v[176:179], v[196:199], v[56:59]
    ds_read_b128 v[228:231], v153 offset:0
    v_add_u32 v115, s88, v11
    s_waitcnt lgkmcnt(10)
    v_mfma_f32_16x16x32_bf16 v[68:71], v[176:179], v[200:203], v[68:71]
    ds_read_b128 v[232:235], v153 offset:2048
    v_add_u32 v118, s89, v11
    s_waitcnt lgkmcnt(10)
    v_mfma_f32_16x16x32_bf16 v[88:91], v[204:207], v[204:207], v[88:91]
    v_mov_b32 v121, v11
    s_waitcnt lgkmcnt(8)
    v_mfma_f32_16x16x32_bf16 v[36:39], v[180:183], v[188:191], v[36:39]
    ds_read_b128 v[236:239], v161
    s_add_u32 m0, s59, 45056
    s_mov_b32 s96, 29056
    buffer_load_dwordx4 v17, s[8:11], s96 offen lds
    s_lshl_b32 s60, s64, 6
    v_mfma_f32_16x16x32_bf16 v[48:51], v[180:183], v[192:195], v[48:51]
    ds_read_b64_tr_b16 v[212:213], v21 offset:19968
    s_add_u32 s60, s60, 158720
    v_mfma_f32_16x16x32_bf16 v[60:63], v[180:183], v[196:199], v[60:63]
    ds_read_b64_tr_b16 v[214:215], v21 offset:20224
    v_lshl_add_u32 v112, v3, 4, s60
    v_mfma_f32_16x16x32_bf16 v[72:75], v[180:183], v[200:203], v[72:75]
    ds_read_b64_tr_b16 v[216:217], v22 offset:19968
    s_lshr_b32 s60, s65, 1
    s_waitcnt lgkmcnt(10)
    v_mfma_f32_16x16x32_bf16 v[40:43], v[184:187], v[188:191], v[40:43]
    ds_read_b64_tr_b16 v[218:219], v22 offset:20224
    s_mul_i32 s60, s60, 21760
    v_mfma_f32_16x16x32_bf16 v[52:55], v[184:187], v[192:195], v[52:55]
    s_and_b32 s61, s65, 1
    v_mfma_f32_16x16x32_bf16 v[64:67], v[184:187], v[196:199], v[64:67]
    s_lshl_b32 s61, s61, 5
    v_mfma_f32_16x16x32_bf16 v[76:79], v[184:187], v[200:203], v[76:79]
    s_add_u32 m0, s57, 4096
    s_mov_b32 s96, 517888
    buffer_load_dwordx4 v18, s[12:15], s96 offen lds
    s_add_u32 s60, s60, s61
    s_waitcnt vmcnt(5) lgkmcnt(0)
    s_barrier
    v_mfma_f32_16x16x32_bf16 v[80:83], v[220:223], v[220:223], v[80:83]
    ds_read_b128 v[188:191], v154 offset:0
    v_add_u32 v11, s60, v10
    v_mfma_f32_16x16x32_bf16 v[32:35], v[208:211], v[220:223], v[32:35]
    ds_read_b64_tr_b16 v[176:177], v20 offset:26624
    v_add_u32 v116, s88, v11
    v_mfma_f32_16x16x32_bf16 v[84:87], v[224:227], v[224:227], v[84:87]
    ds_read_b64_tr_b16 v[178:179], v20 offset:26880
    v_add_u32 v119, s89, v11
    v_mfma_f32_16x16x32_bf16 v[44:47], v[208:211], v[224:227], v[44:47]
    ds_read_b128 v[192:195], v154 offset:2048
    s_lshl_b32 s60, s65, 6
    v_mfma_f32_16x16x32_bf16 v[56:59], v[208:211], v[228:231], v[56:59]
    ds_read_b128 v[196:199], v155 offset:0
    s_add_u32 m0, s57, 13312
    s_mov_b32 s96, 688128
    buffer_load_dwordx4 v18, s[12:15], s96 offen lds
    s_add_u32 s60, s60, 158720
    v_mfma_f32_16x16x32_bf16 v[68:71], v[208:211], v[232:235], v[68:71]
    ds_read_b128 v[200:203], v155 offset:2048
    v_lshl_add_u32 v113, v3, 4, s60
    v_mfma_f32_16x16x32_bf16 v[88:91], v[236:239], v[236:239], v[88:91]
    v_lshlrev_b32 v110, 3, v2
    v_mfma_f32_16x16x32_bf16 v[36:39], v[212:215], v[220:223], v[36:39]
    ds_read_b128 v[204:207], v162
    v_add_u32 v110, 159744, v110
    v_mfma_f32_16x16x32_bf16 v[48:51], v[212:215], v[224:227], v[48:51]
    ds_read_b64_tr_b16 v[180:181], v21 offset:26624
    s_lshl_b32 s60, s94, 7
    v_mfma_f32_16x16x32_bf16 v[60:63], v[212:215], v[228:231], v[60:63]
    ds_read_b64_tr_b16 v[182:183], v21 offset:26880
    s_add_u32 m0, s59, 75904
    s_mov_b32 s96, 512
    buffer_load_dwordx4 v17, s[8:11], s96 offen lds
    v_add_u32 v108, s60, v110
    v_mfma_f32_16x16x32_bf16 v[72:75], v[212:215], v[232:235], v[72:75]
    ds_read_b64_tr_b16 v[184:185], v22 offset:26624
    s_lshl_b32 s60, s95, 7
    v_mfma_f32_16x16x32_bf16 v[40:43], v[216:219], v[220:223], v[40:43]
    ds_read_b64_tr_b16 v[186:187], v22 offset:26880
    v_add_u32 v109, s60, v110
    v_mfma_f32_16x16x32_bf16 v[52:55], v[216:219], v[224:227], v[52:55]
    v_and_b32 v135, 1, v2
    v_mfma_f32_16x16x32_bf16 v[64:67], v[216:219], v[228:231], v[64:67]
    v_lshlrev_b32 v135, 4, v135
    v_mfma_f32_16x16x32_bf16 v[76:79], v[216:219], v[232:235], v[76:79]
    s_add_u32 m0, s57, 15360
    s_mov_b32 s96, 689024
    buffer_load_dwordx4 v18, s[12:15], s96 offen lds
    v_lshlrev_b32 v6, 2, v3
    s_waitcnt lgkmcnt(10)
    v_mfma_f32_16x16x32_bf16 v[80:83], v[188:191], v[188:191], v[80:83]
    ds_read_b128 v[220:223], v156 offset:0
    v_sub_u32 v6, v6, v2
    s_waitcnt lgkmcnt(9)
    v_mfma_f32_16x16x32_bf16 v[32:35], v[176:179], v[188:191], v[32:35]
    ds_read_b64_tr_b16 v[208:209], v20 offset:33280
    v_mov_b32 v7, 0xf149f2ca
    s_waitcnt lgkmcnt(9)
    v_mfma_f32_16x16x32_bf16 v[84:87], v[192:195], v[192:195], v[84:87]
    ds_read_b64_tr_b16 v[210:211], v20 offset:33536
    s_add_u32 s60, s50, s4
    v_mfma_f32_16x16x32_bf16 v[44:47], v[176:179], v[192:195], v[44:47]
    ds_read_b128 v[224:227], v156 offset:2048
    s_cmp_eq_u32 s60, 0
    s_cselect_b64 s[90:91], 0, -1
    s_waitcnt lgkmcnt(10)
    v_mfma_f32_16x16x32_bf16 v[56:59], v[176:179], v[196:199], v[56:59]
    ds_read_b128 v[228:231], v157 offset:0
    v_add_u32 v8, 0, v6
    s_waitcnt lgkmcnt(10)
    v_mfma_f32_16x16x32_bf16 v[68:71], v[176:179], v[200:203], v[68:71]
    ds_read_b128 v[232:235], v157 offset:2048
    v_and_b32 v9, 1, v8
    s_waitcnt lgkmcnt(10)
    v_mfma_f32_16x16x32_bf16 v[88:91], v[204:207], v[204:207], v[88:91]
    v_cmp_eq_u32 s[70:71], 0, v9
    s_waitcnt lgkmcnt(8)
    v_mfma_f32_16x16x32_bf16 v[36:39], v[180:183], v[188:191], v[36:39]
    ds_read_b128 v[236:239], v163
    s_add_u32 m0, s59, 80000
    s_mov_b32 s96, 29184
    buffer_load_dwordx4 v17, s[8:11], s96 offen lds
    v_cmp_le_i32 s[72:73], 2, v8
    v_mfma_f32_16x16x32_bf16 v[48:51], v[180:183], v[192:195], v[48:51]
    ds_read_b64_tr_b16 v[212:213], v21 offset:33280
    v_cmp_ge_i32 s[74:75], 0, v8
    v_mfma_f32_16x16x32_bf16 v[60:63], v[180:183], v[196:199], v[60:63]
    ds_read_b64_tr_b16 v[214:215], v21 offset:33536
    s_and_b64 s[72:73], s[72:73], s[70:71]
    v_mfma_f32_16x16x32_bf16 v[72:75], v[180:183], v[200:203], v[72:75]
    ds_read_b64_tr_b16 v[216:217], v22 offset:33280
    s_and_b64 s[74:75], s[74:75], s[70:71]
    s_waitcnt lgkmcnt(10)
    v_mfma_f32_16x16x32_bf16 v[40:43], v[184:187], v[188:191], v[40:43]
    ds_read_b64_tr_b16 v[218:219], v22 offset:33536
    v_cndmask_b32 v100, v7, 0, s[72:73]
    v_mfma_f32_16x16x32_bf16 v[52:55], v[184:187], v[192:195], v[52:55]
    v_cndmask_b32 v104, v7, 0, s[74:75]
    v_mfma_f32_16x16x32_bf16 v[64:67], v[184:187], v[196:199], v[64:67]
    v_cndmask_b32 v96, v7, v100, s[90:91]
    v_mfma_f32_16x16x32_bf16 v[76:79], v[184:187], v[200:203], v[76:79]
    s_add_u32 m0, s57, 17408
    s_mov_b32 s96, 689920
    buffer_load_dwordx4 v18, s[12:15], s96 offen lds
    v_add_u32 v8, 1, v6
    s_waitcnt vmcnt(5) lgkmcnt(0)
    s_barrier
    v_mfma_f32_16x16x32_bf16 v[80:83], v[220:223], v[220:223], v[80:83]
    ds_read_b128 v[188:191], v146 offset:0
    v_and_b32 v9, 1, v8
    v_mfma_f32_16x16x32_bf16 v[32:35], v[208:211], v[220:223], v[32:35]
    ds_read_b64_tr_b16 v[176:177], v20 offset:0
    v_cmp_eq_u32 s[70:71], 0, v9
    v_mfma_f32_16x16x32_bf16 v[84:87], v[224:227], v[224:227], v[84:87]
    ds_read_b64_tr_b16 v[178:179], v20 offset:256
    v_cmp_le_i32 s[72:73], 2, v8
    v_mfma_f32_16x16x32_bf16 v[44:47], v[208:211], v[224:227], v[44:47]
    ds_read_b128 v[192:195], v146 offset:2048
    v_cmp_ge_i32 s[74:75], 0, v8
    v_mfma_f32_16x16x32_bf16 v[56:59], v[208:211], v[228:231], v[56:59]
    ds_read_b128 v[196:199], v147 offset:0
    s_add_u32 m0, s57, 26624
    s_mov_b32 s96, 860160
    buffer_load_dwordx4 v18, s[12:15], s96 offen lds
    s_and_b64 s[72:73], s[72:73], s[70:71]
    v_mfma_f32_16x16x32_bf16 v[68:71], v[208:211], v[232:235], v[68:71]
    ds_read_b128 v[200:203], v147 offset:2048
    s_and_b64 s[74:75], s[74:75], s[70:71]
    v_mfma_f32_16x16x32_bf16 v[88:91], v[236:239], v[236:239], v[88:91]
    v_cndmask_b32 v101, v7, 0, s[72:73]
    v_mfma_f32_16x16x32_bf16 v[36:39], v[212:215], v[220:223], v[36:39]
    ds_read_b128 v[204:207], v158
    v_cndmask_b32 v105, v7, 0, s[74:75]
    v_mfma_f32_16x16x32_bf16 v[48:51], v[212:215], v[224:227], v[48:51]
    ds_read_b64_tr_b16 v[180:181], v21 offset:0
    v_cndmask_b32 v97, v7, v101, s[90:91]
    v_mfma_f32_16x16x32_bf16 v[60:63], v[212:215], v[228:231], v[60:63]
    ds_read_b64_tr_b16 v[182:183], v21 offset:256
    s_add_u32 m0, s59, 110848
    s_mov_b32 s96, 640
    buffer_load_dwordx4 v17, s[8:11], s96 offen lds
    v_add_u32 v8, 2, v6
    v_mfma_f32_16x16x32_bf16 v[72:75], v[212:215], v[232:235], v[72:75]
    ds_read_b64_tr_b16 v[184:185], v22 offset:0
    v_and_b32 v9, 1, v8
    v_mfma_f32_16x16x32_bf16 v[40:43], v[216:219], v[220:223], v[40:43]
    ds_read_b64_tr_b16 v[186:187], v22 offset:256
    v_cmp_eq_u32 s[70:71], 0, v9
    v_mfma_f32_16x16x32_bf16 v[52:55], v[216:219], v[224:227], v[52:55]
    v_cmp_le_i32 s[72:73], 2, v8
    v_mfma_f32_16x16x32_bf16 v[64:67], v[216:219], v[228:231], v[64:67]
    v_cmp_ge_i32 s[74:75], 0, v8
    v_mfma_f32_16x16x32_bf16 v[76:79], v[216:219], v[232:235], v[76:79]
    s_add_u32 m0, s57, 28672
    s_mov_b32 s96, 861056
    buffer_load_dwordx4 v18, s[12:15], s96 offen lds
    s_and_b64 s[72:73], s[72:73], s[70:71]
    s_waitcnt lgkmcnt(10)
    v_mfma_f32_16x16x32_bf16 v[80:83], v[188:191], v[188:191], v[80:83]
    ds_read_b128 v[220:223], v148 offset:0
    s_and_b64 s[74:75], s[74:75], s[70:71]
    s_waitcnt lgkmcnt(9)
    v_mfma_f32_16x16x32_bf16 v[32:35], v[176:179], v[188:191], v[32:35]
    ds_read_b64_tr_b16 v[208:209], v20 offset:6656
    v_cndmask_b32 v102, v7, 0, s[72:73]
    s_waitcnt lgkmcnt(9)
    v_mfma_f32_16x16x32_bf16 v[84:87], v[192:195], v[192:195], v[84:87]
    ds_read_b64_tr_b16 v[210:211], v20 offset:6912
    v_cndmask_b32 v106, v7, 0, s[74:75]
    v_mfma_f32_16x16x32_bf16 v[44:47], v[176:179], v[192:195], v[44:47]
    ds_read_b128 v[224:227], v148 offset:2048
    v_cndmask_b32 v98, v7, v102, s[90:91]
    s_waitcnt lgkmcnt(10)
    v_mfma_f32_16x16x32_bf16 v[56:59], v[176:179], v[196:199], v[56:59]
    ds_read_b128 v[228:231], v149 offset:0
    v_add_u32 v8, 3, v6
    s_waitcnt lgkmcnt(10)
    v_mfma_f32_16x16x32_bf16 v[68:71], v[176:179], v[200:203], v[68:71]
    ds_read_b128 v[232:235], v149 offset:2048
    v_and_b32 v9, 1, v8
    s_waitcnt lgkmcnt(10)
    v_mfma_f32_16x16x32_bf16 v[88:91], v[204:207], v[204:207], v[88:91]
    v_cmp_eq_u32 s[70:71], 0, v9
    s_waitcnt lgkmcnt(8)
    v_mfma_f32_16x16x32_bf16 v[36:39], v[180:183], v[188:191], v[36:39]
    ds_read_b128 v[236:239], v159
    s_add_u32 m0, s59, 114944
    s_mov_b32 s96, 29312
    buffer_load_dwordx4 v17, s[8:11], s96 offen lds
    v_cmp_le_i32 s[72:73], 2, v8
    v_mfma_f32_16x16x32_bf16 v[48:51], v[180:183], v[192:195], v[48:51]
    ds_read_b64_tr_b16 v[212:213], v21 offset:6656
    v_cmp_ge_i32 s[74:75], 0, v8
    v_mfma_f32_16x16x32_bf16 v[60:63], v[180:183], v[196:199], v[60:63]
    ds_read_b64_tr_b16 v[214:215], v21 offset:6912
    s_and_b64 s[72:73], s[72:73], s[70:71]
    v_mfma_f32_16x16x32_bf16 v[72:75], v[180:183], v[200:203], v[72:75]
    ds_read_b64_tr_b16 v[216:217], v22 offset:6656
    s_and_b64 s[74:75], s[74:75], s[70:71]
    s_waitcnt lgkmcnt(10)
    v_mfma_f32_16x16x32_bf16 v[40:43], v[184:187], v[188:191], v[40:43]
    ds_read_b64_tr_b16 v[218:219], v22 offset:6912
    v_cndmask_b32 v103, v7, 0, s[72:73]
    v_mfma_f32_16x16x32_bf16 v[52:55], v[184:187], v[192:195], v[52:55]
    v_cndmask_b32 v107, v7, 0, s[74:75]
    v_mfma_f32_16x16x32_bf16 v[64:67], v[184:187], v[196:199], v[64:67]
    v_cndmask_b32 v99, v7, v103, s[90:91]
    v_mfma_f32_16x16x32_bf16 v[76:79], v[184:187], v[200:203], v[76:79]
    s_add_u32 m0, s57, 30720
    s_mov_b32 s96, 861952
    buffer_load_dwordx4 v18, s[12:15], s96 offen lds
    v_lshrrev_b32 v5, 2, v2
    s_waitcnt vmcnt(5) lgkmcnt(0)
    s_barrier
    v_mfma_f32_16x16x32_bf16 v[80:83], v[220:223], v[220:223], v[80:83]
    ds_read_b128 v[188:191], v150 offset:0
    v_cmp_eq_u32 s[90:91], v5, v3
    v_mfma_f32_16x16x32_bf16 v[32:35], v[208:211], v[220:223], v[32:35]
    ds_read_b64_tr_b16 v[176:177], v20 offset:13312
    v_and_b32 v5, 3, v2
    v_mfma_f32_16x16x32_bf16 v[84:87], v[224:227], v[224:227], v[84:87]
    ds_read_b64_tr_b16 v[178:179], v20 offset:13568
    v_cmp_eq_u32 s[92:93], 0, v5
    v_mfma_f32_16x16x32_bf16 v[44:47], v[208:211], v[224:227], v[44:47]
    ds_read_b128 v[192:195], v150 offset:2048
    v_cmp_eq_u32 s[70:71], 1, v5
    v_mfma_f32_16x16x32_bf16 v[56:59], v[208:211], v[228:231], v[56:59]
    ds_read_b128 v[196:199], v151 offset:0
    s_add_u32 m0, s57, 0
    s_mov_b32 s96, 1032192
    buffer_load_dwordx4 v18, s[12:15], s96 offen lds
    v_cmp_eq_u32 s[72:73], 2, v5
    v_mfma_f32_16x16x32_bf16 v[68:71], v[208:211], v[232:235], v[68:71]
    ds_read_b128 v[200:203], v151 offset:2048
    v_cmp_eq_u32 s[74:75], 3, v5
    v_mfma_f32_16x16x32_bf16 v[88:91], v[236:239], v[236:239], v[88:91]
    s_and_b64 s[92:93], s[92:93], s[90:91]
    v_mfma_f32_16x16x32_bf16 v[36:39], v[212:215], v[220:223], v[36:39]
    ds_read_b128 v[204:207], v160
    s_and_b64 s[70:71], s[70:71], s[90:91]
    v_mfma_f32_16x16x32_bf16 v[48:51], v[212:215], v[224:227], v[48:51]
    ds_read_b64_tr_b16 v[180:181], v21 offset:13312
    s_and_b64 s[72:73], s[72:73], s[90:91]
    v_mfma_f32_16x16x32_bf16 v[60:63], v[212:215], v[228:231], v[60:63]
    ds_read_b64_tr_b16 v[182:183], v21 offset:13568
    s_add_u32 m0, s59, 40960
    s_mov_b32 s96, 768
    buffer_load_dwordx4 v17, s[8:11], s96 offen lds
    s_and_b64 s[74:75], s[74:75], s[90:91]
    v_mfma_f32_16x16x32_bf16 v[72:75], v[212:215], v[232:235], v[72:75]
    ds_read_b64_tr_b16 v[184:185], v22 offset:13312
    s_lshl_b32 s62, s45, 1
    v_mfma_f32_16x16x32_bf16 v[40:43], v[216:219], v[220:223], v[40:43]
    ds_read_b64_tr_b16 v[186:187], v22 offset:13568
    s_add_u32 s62, s62, 1
    v_mfma_f32_16x16x32_bf16 v[52:55], v[216:219], v[224:227], v[52:55]
    s_cmp_eq_u32 s63, s62
    s_cselect_b64 s[88:89], s[68:69], 0
    v_mfma_f32_16x16x32_bf16 v[64:67], v[216:219], v[228:231], v[64:67]
    s_cmp_eq_u32 s64, s62
    s_cselect_b64 s[90:91], s[68:69], 0
    v_mfma_f32_16x16x32_bf16 v[76:79], v[216:219], v[232:235], v[76:79]
    s_add_u32 m0, s57, 2048
    s_mov_b32 s96, 1033088
    buffer_load_dwordx4 v18, s[12:15], s96 offen lds
    s_cmp_eq_u32 s65, s62
    s_cselect_b64 s[94:95], s[68:69], 0
    s_waitcnt lgkmcnt(10)
    v_mfma_f32_16x16x32_bf16 v[80:83], v[188:191], v[188:191], v[80:83]
    ds_read_b128 v[220:223], v152 offset:0
    s_mov_b32 s62, 0x3e8b97f6
    s_waitcnt lgkmcnt(9)
    v_mfma_f32_16x16x32_bf16 v[32:35], v[176:179], v[188:191], v[32:35]
    ds_read_b64_tr_b16 v[208:209], v20 offset:19968
    s_waitcnt lgkmcnt(9)
    v_mfma_f32_16x16x32_bf16 v[84:87], v[192:195], v[192:195], v[84:87]
    ds_read_b64_tr_b16 v[210:211], v20 offset:20224
    v_mfma_f32_16x16x32_bf16 v[44:47], v[176:179], v[192:195], v[44:47]
    ds_read_b128 v[224:227], v152 offset:2048
    s_waitcnt lgkmcnt(10)
    v_mfma_f32_16x16x32_bf16 v[56:59], v[176:179], v[196:199], v[56:59]
    ds_read_b128 v[228:231], v153 offset:0
    s_add_u32 m0, s59, 45056
    s_mov_b32 s96, 29440
    buffer_load_dwordx4 v17, s[8:11], s96 offen lds
    s_waitcnt lgkmcnt(10)
    v_mfma_f32_16x16x32_bf16 v[68:71], v[176:179], v[200:203], v[68:71]
    ds_read_b128 v[232:235], v153 offset:2048
    s_waitcnt lgkmcnt(10)
    v_mfma_f32_16x16x32_bf16 v[88:91], v[204:207], v[204:207], v[88:91]
    s_waitcnt lgkmcnt(8)
    v_mfma_f32_16x16x32_bf16 v[36:39], v[180:183], v[188:191], v[36:39]
    ds_read_b128 v[236:239], v161
    v_mfma_f32_16x16x32_bf16 v[48:51], v[180:183], v[192:195], v[48:51]
    ds_read_b64_tr_b16 v[212:213], v21 offset:19968
    v_mfma_f32_16x16x32_bf16 v[60:63], v[180:183], v[196:199], v[60:63]
    ds_read_b64_tr_b16 v[214:215], v21 offset:20224
    s_add_u32 m0, s57, 4096
    s_mov_b32 s96, 1033984
    buffer_load_dwordx4 v18, s[12:15], s96 offen lds
    v_mfma_f32_16x16x32_bf16 v[72:75], v[180:183], v[200:203], v[72:75]
    ds_read_b64_tr_b16 v[216:217], v22 offset:19968
    s_waitcnt lgkmcnt(10)
    v_mfma_f32_16x16x32_bf16 v[40:43], v[184:187], v[188:191], v[40:43]
    ds_read_b64_tr_b16 v[218:219], v22 offset:20224
    v_mfma_f32_16x16x32_bf16 v[52:55], v[184:187], v[192:195], v[52:55]
    v_mfma_f32_16x16x32_bf16 v[64:67], v[184:187], v[196:199], v[64:67]
    v_mfma_f32_16x16x32_bf16 v[76:79], v[184:187], v[200:203], v[76:79]
    v_lshrrev_b32 v134, 3, v1
    v_mul_u32_u24 v134, 56320, v134
    v_lshl_add_u32 v134, v1, 7, v134
    s_mov_b64 exec, 0xffff
    buffer_load_dword v31, v134, s[36:39], s84 offen sc1
    s_mov_b64 exec, -1
    s_waitcnt vmcnt(6) lgkmcnt(0)
    s_barrier
    s_nop 3
    v_mfma_f32_16x16x32_bf16 v[80:83], v[220:223], v[220:223], v[80:83]
    ds_read_b128 v[188:191], v154 offset:0
    v_mfma_f32_16x16x32_bf16 v[32:35], v[208:211], v[220:223], v[32:35]
    ds_read_b64_tr_b16 v[176:177], v20 offset:26624
    v_mfma_f32_16x16x32_bf16 v[84:87], v[224:227], v[224:227], v[84:87]
    ds_read_b64_tr_b16 v[178:179], v20 offset:26880
    v_mfma_f32_16x16x32_bf16 v[44:47], v[208:211], v[224:227], v[44:47]
    ds_read_b128 v[192:195], v154 offset:2048
    v_mfma_f32_16x16x32_bf16 v[56:59], v[208:211], v[228:231], v[56:59]
    ds_read_b128 v[196:199], v155 offset:0
    s_mov_b64 exec, 0xffffffff
    buffer_load_dword v14, v124, s[36:39], s54 offen sc1
    s_mov_b64 exec, -1
    s_nop 5
    v_mfma_f32_16x16x32_bf16 v[68:71], v[208:211], v[232:235], v[68:71]
    ds_read_b128 v[200:203], v155 offset:2048
    v_mfma_f32_16x16x32_bf16 v[88:91], v[236:239], v[236:239], v[88:91]
    v_mfma_f32_16x16x32_bf16 v[36:39], v[212:215], v[220:223], v[36:39]
    ds_read_b128 v[204:207], v162
    v_mfma_f32_16x16x32_bf16 v[48:51], v[212:215], v[224:227], v[48:51]
    ds_read_b64_tr_b16 v[180:181], v21 offset:26624
    v_mfma_f32_16x16x32_bf16 v[60:63], v[212:215], v[228:231], v[60:63]
    ds_read_b64_tr_b16 v[182:183], v21 offset:26880
    s_add_u32 m0, s58, 75904
    s_mov_b32 s96, 0
    buffer_load_dwordx4 v29, s[24:27], s96 offen lds
    v_mfma_f32_16x16x32_bf16 v[72:75], v[212:215], v[232:235], v[72:75]
    ds_read_b64_tr_b16 v[184:185], v22 offset:26624
    v_mfma_f32_16x16x32_bf16 v[40:43], v[216:219], v[220:223], v[40:43]
    ds_read_b64_tr_b16 v[186:187], v22 offset:26880
    v_mfma_f32_16x16x32_bf16 v[52:55], v[216:219], v[224:227], v[52:55]
    v_mfma_f32_16x16x32_bf16 v[64:67], v[216:219], v[228:231], v[64:67]
    v_mfma_f32_16x16x32_bf16 v[76:79], v[216:219], v[232:235], v[76:79]
    s_add_u32 m0, s58, 84096
    s_mov_b32 s96, 229376
    buffer_load_dwordx4 v29, s[24:27], s96 offen lds
    s_waitcnt lgkmcnt(10)
    v_mfma_f32_16x16x32_bf16 v[80:83], v[188:191], v[188:191], v[80:83]
    ds_read_b128 v[220:223], v156 offset:0
    s_waitcnt lgkmcnt(9)
    v_mfma_f32_16x16x32_bf16 v[32:35], v[176:179], v[188:191], v[32:35]
    ds_read_b64_tr_b16 v[208:209], v20 offset:33280
    s_waitcnt lgkmcnt(9)
    v_mfma_f32_16x16x32_bf16 v[84:87], v[192:195], v[192:195], v[84:87]
    ds_read_b64_tr_b16 v[210:211], v20 offset:33536
    v_mfma_f32_16x16x32_bf16 v[44:47], v[176:179], v[192:195], v[44:47]
    ds_read_b128 v[224:227], v156 offset:2048
    s_waitcnt lgkmcnt(10)
    v_mfma_f32_16x16x32_bf16 v[56:59], v[176:179], v[196:199], v[56:59]
    ds_read_b128 v[228:231], v157 offset:0
    s_waitcnt lgkmcnt(10)
    v_mfma_f32_16x16x32_bf16 v[68:71], v[176:179], v[200:203], v[68:71]
    ds_read_b128 v[232:235], v157 offset:2048
    s_waitcnt lgkmcnt(10)
    v_mfma_f32_16x16x32_bf16 v[88:91], v[204:207], v[204:207], v[88:91]
    s_waitcnt lgkmcnt(8)
    v_mfma_f32_16x16x32_bf16 v[36:39], v[180:183], v[188:191], v[36:39]
    ds_read_b128 v[236:239], v163
    s_add_u32 m0, s58, 92288
    s_mov_b32 s96, 458752
    buffer_load_dwordx4 v29, s[24:27], s96 offen lds
    v_mfma_f32_16x16x32_bf16 v[48:51], v[180:183], v[192:195], v[48:51]
    ds_read_b64_tr_b16 v[212:213], v21 offset:33280
    v_mfma_f32_16x16x32_bf16 v[60:63], v[180:183], v[196:199], v[60:63]
    ds_read_b64_tr_b16 v[214:215], v21 offset:33536
    v_mfma_f32_16x16x32_bf16 v[72:75], v[180:183], v[200:203], v[72:75]
    ds_read_b64_tr_b16 v[216:217], v22 offset:33280
    s_waitcnt lgkmcnt(10)
    v_mfma_f32_16x16x32_bf16 v[40:43], v[184:187], v[188:191], v[40:43]
    ds_read_b64_tr_b16 v[218:219], v22 offset:33536
    v_mfma_f32_16x16x32_bf16 v[52:55], v[184:187], v[192:195], v[52:55]
    v_mfma_f32_16x16x32_bf16 v[64:67], v[184:187], v[196:199], v[64:67]
    v_mfma_f32_16x16x32_bf16 v[76:79], v[184:187], v[200:203], v[76:79]
    s_add_u32 m0, s58, 100480
    s_mov_b32 s96, 688128
    buffer_load_dwordx4 v29, s[24:27], s96 offen lds
    s_waitcnt vmcnt(6) lgkmcnt(0)
    s_barrier
    v_mfma_f32_16x16x32_bf16 v[80:83], v[220:223], v[220:223], v[80:83]
    ds_read_b128 v[188:191], v146 offset:0
    v_mfma_f32_16x16x32_bf16 v[32:35], v[208:211], v[220:223], v[32:35]
    ds_read_b64_tr_b16 v[176:177], v20 offset:0
    v_mfma_f32_16x16x32_bf16 v[84:87], v[224:227], v[224:227], v[84:87]
    ds_read_b64_tr_b16 v[178:179], v20 offset:256
    v_mfma_f32_16x16x32_bf16 v[44:47], v[208:211], v[224:227], v[44:47]
    ds_read_b128 v[192:195], v146 offset:2048
    v_mfma_f32_16x16x32_bf16 v[56:59], v[208:211], v[228:231], v[56:59]
    ds_read_b128 v[196:199], v147 offset:0
    s_add_u32 m0, s58, 108672
    s_mov_b32 s96, 917504
    buffer_load_dwordx4 v29, s[24:27], s96 offen lds
    v_mfma_f32_16x16x32_bf16 v[68:71], v[208:211], v[232:235], v[68:71]
    ds_read_b128 v[200:203], v147 offset:2048
    v_mfma_f32_16x16x32_bf16 v[88:91], v[236:239], v[236:239], v[88:91]
    v_mfma_f32_16x16x32_bf16 v[36:39], v[212:215], v[220:223], v[36:39]
    ds_read_b128 v[204:207], v158
    v_mfma_f32_16x16x32_bf16 v[48:51], v[212:215], v[224:227], v[48:51]
    ds_read_b64_tr_b16 v[180:181], v21 offset:0
    v_mfma_f32_16x16x32_bf16 v[60:63], v[212:215], v[228:231], v[60:63]
    ds_read_b64_tr_b16 v[182:183], v21 offset:256
    s_add_u32 m0, s58, 116864
    s_mov_b32 s96, 1146880
    buffer_load_dwordx4 v29, s[24:27], s96 offen lds
    v_mfma_f32_16x16x32_bf16 v[72:75], v[212:215], v[232:235], v[72:75]
    ds_read_b64_tr_b16 v[184:185], v22 offset:0
    v_mfma_f32_16x16x32_bf16 v[40:43], v[216:219], v[220:223], v[40:43]
    ds_read_b64_tr_b16 v[186:187], v22 offset:256
    v_mfma_f32_16x16x32_bf16 v[52:55], v[216:219], v[224:227], v[52:55]
    v_mfma_f32_16x16x32_bf16 v[64:67], v[216:219], v[228:231], v[64:67]
    v_mfma_f32_16x16x32_bf16 v[76:79], v[216:219], v[232:235], v[76:79]
    s_add_u32 m0, s58, 125056
    s_mov_b32 s96, 1376256
    buffer_load_dwordx4 v29, s[24:27], s96 offen lds
    s_waitcnt lgkmcnt(10)
    v_mfma_f32_16x16x32_bf16 v[80:83], v[188:191], v[188:191], v[80:83]
    ds_read_b128 v[220:223], v148 offset:0
    ds_read_b64_tr_b16 v[208:209], v20 offset:6656
    s_waitcnt lgkmcnt(10)
    v_mfma_f32_16x16x32_bf16 v[32:35], v[176:179], v[188:191], v[32:35]
    ds_read_b64_tr_b16 v[210:211], v20 offset:6912
    ds_read_b128 v[224:227], v148 offset:2048
    s_waitcnt lgkmcnt(11)
    v_mfma_f32_16x16x32_bf16 v[84:87], v[192:195], v[192:195], v[84:87]
    ds_read_b128 v[228:231], v149 offset:0
    v_mfma_f32_16x16x32_bf16 v[44:47], v[176:179], v[192:195], v[44:47]
    ds_read_b128 v[232:235], v149 offset:2048
    ds_read_b128 v[236:239], v159
    s_waitcnt lgkmcnt(11)
    v_mfma_f32_16x16x32_bf16 v[88:91], v[204:207], v[204:207], v[88:91]
    ds_read_b64_tr_b16 v[212:213], v21 offset:6656
    s_waitcnt lgkmcnt(10)
    v_mfma_f32_16x16x32_bf16 v[36:39], v[180:183], v[188:191], v[36:39]
    ds_read_b64_tr_b16 v[214:215], v21 offset:6912
    ds_read_b64_tr_b16 v[216:217], v22 offset:6656
    v_mfma_f32_16x16x32_bf16 v[48:51], v[180:183], v[192:195], v[48:51]
    ds_read_b64_tr_b16 v[218:219], v22 offset:6912
    s_waitcnt lgkmcnt(11)
    v_mfma_f32_16x16x32_bf16 v[40:43], v[184:187], v[188:191], v[40:43]
    v_mfma_f32_16x16x32_bf16 v[52:55], v[184:187], v[192:195], v[52:55]
    v_mfma_f32_16x16x32_bf16 v[56:59], v[176:179], v[196:199], v[56:59]
    v_mfma_f32_16x16x32_bf16 v[68:71], v[176:179], v[200:203], v[68:71]
    v_mfma_f32_16x16x32_bf16 v[60:63], v[180:183], v[196:199], v[60:63]
    s_waitcnt lgkmcnt(0)
    v_mfma_f32_16x16x32_bf16 v[80:83], v[220:223], v[220:223], v[80:83]
    v_mfma_f32_16x16x32_bf16 v[32:35], v[208:211], v[220:223], v[32:35]
    v_mfma_f32_16x16x32_bf16 v[84:87], v[224:227], v[224:227], v[84:87]
    v_mfma_f32_16x16x32_bf16 v[44:47], v[208:211], v[224:227], v[44:47]
    v_mfma_f32_16x16x32_bf16 v[88:91], v[236:239], v[236:239], v[88:91]
    v_mfma_f32_16x16x32_bf16 v[36:39], v[212:215], v[220:223], v[36:39]
    v_mfma_f32_16x16x32_bf16 v[48:51], v[212:215], v[224:227], v[48:51]
    v_mfma_f32_16x16x32_bf16 v[40:43], v[216:219], v[220:223], v[40:43]
    v_mfma_f32_16x16x32_bf16 v[52:55], v[216:219], v[224:227], v[52:55]
    v_mfma_f32_16x16x32_bf16 v[72:75], v[180:183], v[200:203], v[72:75]
    v_mfma_f32_16x16x32_bf16 v[64:67], v[184:187], v[196:199], v[64:67]
    s_nop 1
    v_mov_b32 v248, v88
    v_cndmask_b32 v241, 0, v80, s[92:93]
    v_cndmask_b32 v243, 0, v84, s[92:93]
    v_add_f32 v126, v32, v33
    v_add_f32 v130, v44, v45
    v_cndmask_b32 v249, 0, v88, s[92:93]
    v_cndmask_b32 v241, v241, v81, s[70:71]
    v_cndmask_b32 v243, v243, v85, s[70:71]
    v_add_f32 v127, v36, v37
    v_add_f32 v131, v48, v49
    v_cndmask_b32 v249, v249, v89, s[70:71]
    v_cndmask_b32 v241, v241, v82, s[72:73]
    v_cndmask_b32 v243, v243, v86, s[72:73]
    v_mfma_f32_16x16x32_bf16 v[76:79], v[184:187], v[200:203], v[76:79]
    v_add_f32 v128, v40, v41
    v_add_f32 v132, v52, v53
    v_cndmask_b32 v249, v249, v90, s[72:73]
    v_cndmask_b32 v241, v241, v83, s[74:75]
    v_cndmask_b32 v243, v243, v87, s[74:75]
    v_cndmask_b32 v240, 0, v126, s[88:89]
    v_cndmask_b32 v242, 0, v130, s[88:89]
    v_cndmask_b32 v249, v249, v91, s[74:75]
    v_mov_b32 v8, v241
    v_mov_b32 v9, v243
    v_cndmask_b32 v240, v240, v127, s[90:91]
    v_cndmask_b32 v242, v242, v131, s[90:91]
    v_mov_b32 v10, v249
    v_mfma_f32_16x16x32_bf16 v[56:59], v[208:211], v[228:231], v[56:59]
    v_permlane32_swap_b32 v241, v8
    v_permlane32_swap_b32 v243, v9
    v_cndmask_b32 v240, v240, v128, s[94:95]
    v_cndmask_b32 v242, v242, v132, s[94:95]
    v_permlane32_swap_b32 v249, v10
    v_add_f32 v241, v241, v8
    v_add_f32 v243, v243, v9
    v_mov_b32 v6, v240
    v_mov_b32 v7, v242
    v_add_f32 v249, v249, v10
    v_mov_b32 v8, v241
    v_mov_b32 v9, v243
    v_permlane32_swap_b32 v240, v6
    v_mfma_f32_16x16x32_bf16 v[68:71], v[208:211], v[232:235], v[68:71]
    v_permlane32_swap_b32 v242, v7
    v_mov_b32 v10, v249
    v_permlane16_swap_b32 v241, v8
    v_permlane16_swap_b32 v243, v9
    v_add_f32 v240, v240, v6
    v_add_f32 v242, v242, v7
    v_permlane16_swap_b32 v249, v10
    v_add_f32 v241, v241, v8
    v_add_f32 v243, v243, v9
    v_mov_b32 v6, v240
    v_mov_b32 v7, v242
    v_add_f32 v249, v249, v10
    v_permlane16_swap_b32 v240, v6
    v_mfma_f32_16x16x32_bf16 v[60:63], v[212:215], v[228:231], v[60:63]
    v_permlane16_swap_b32 v242, v7
    v_add_f32 v240, v240, v6
    v_add_f32 v242, v242, v7
    v_mul_f32 v240, 0x3b124925, v240
    v_mul_f32 v242, 0x3b124925, v242
    v_mul_f32 v248, 0x3b124925, v248
    v_mul_f32 v241, 0x3b124925, v241
    v_mul_f32 v243, 0x3b124925, v243
    v_mul_f32 v249, 0x3b124925, v249
    v_fma_f32 v241, -v240, v240, v241
    v_fma_f32 v243, -v242, v242, v243
    v_fma_f32 v249, -v248, v248, v249
    v_max_f32 v241, 0, v241
    v_mfma_f32_16x16x32_bf16 v[72:75], v[212:215], v[232:235], v[72:75]
    v_max_f32 v243, 0, v243
    v_max_f32 v249, 0, v249
    v_cvt_pk_bf16_f32 v241, v241, v241
    v_cvt_pk_bf16_f32 v243, v243, v243
    v_cvt_pk_bf16_f32 v249, v249, v249
    v_lshlrev_b32 v241, 16, v241
    v_lshlrev_b32 v243, 16, v243
    v_lshlrev_b32 v249, 16, v249
    v_add_f32 v241, 0x3727c5ac, v241
    v_add_f32 v243, 0x3727c5ac, v243
    v_add_f32 v249, 0x3727c5ac, v249
    v_cvt_pk_bf16_f32 v241, v241, v241
    v_cvt_pk_bf16_f32 v243, v243, v243
    v_mfma_f32_16x16x32_bf16 v[64:67], v[216:219], v[228:231], v[64:67]
    v_cvt_pk_bf16_f32 v249, v249, v249
    v_lshlrev_b32 v241, 16, v241
    v_lshlrev_b32 v243, 16, v243
    v_lshlrev_b32 v249, 16, v249
    v_sqrt_f32 v241, v241
    v_sqrt_f32 v243, v243
    v_sqrt_f32 v249, v249
    v_cvt_pk_bf16_f32 v240, v240, v240
    v_cvt_pk_bf16_f32 v242, v242, v242
    v_cvt_pk_bf16_f32 v248, v248, v248
    v_lshlrev_b32 v240, 16, v240
    v_lshlrev_b32 v242, 16, v242
    v_lshlrev_b32 v248, 16, v248
    v_mfma_f32_16x16x32_bf16 v[76:79], v[216:219], v[232:235], v[76:79]
    v_cvt_pk_bf16_f32 v241, v241, v241
    v_cvt_pk_bf16_f32 v243, v243, v243
    v_cvt_pk_bf16_f32 v249, v249, v249
    v_lshlrev_b32 v241, 16, v241
    v_lshlrev_b32 v243, 16, v243
    v_lshlrev_b32 v249, 16, v249
    v_rcp_f32 v241, v241
    v_rcp_f32 v243, v243
    v_rcp_f32 v249, v249
    v_mul_f32_e64 v240, -v240, v241
    v_mul_f32_e64 v242, -v242, v243
    v_mul_f32_e64 v248, -v248, v249
    s_mov_b64 exec, 0xffff
    ds_write_b64 v108, v[240:241] offset:128
    ds_write_b64 v108, v[242:243] offset:256
    ds_write_b64 v110, v[248:249]
    s_mov_b64 exec, -1
    s_waitcnt lgkmcnt(0)
    s_barrier
    ds_read_b128 v[176:179], v111
    ds_read_b128 v[180:183], v112
    ds_read_b128 v[184:187], v113
    ds_read_b64 v[244:245], v109 offset:128
    ds_read_b64 v[246:247], v109 offset:256
    v_mul_f32 v32, v241, v32
    v_mul_f32 v33, v241, v33
    v_mul_f32 v34, v241, v34
    v_mul_f32 v35, v241, v35
    v_mul_f32 v36, v241, v36
    v_mul_f32 v37, v241, v37
    v_mul_f32 v38, v241, v38
    v_mul_f32 v39, v241, v39
    v_mul_f32 v40, v241, v40
    v_mul_f32 v41, v241, v41
    v_mul_f32 v42, v241, v42
    v_mul_f32 v43, v241, v43
    v_mul_f32 v44, v243, v44
    v_mul_f32 v45, v243, v45
    v_mul_f32 v46, v243, v46
    v_mul_f32 v47, v243, v47
    v_mul_f32 v48, v243, v48
    v_mul_f32 v49, v243, v49
    v_mul_f32 v50, v243, v50
    v_mul_f32 v51, v243, v51
    v_mul_f32 v52, v243, v52
    v_mul_f32 v53, v243, v53
    v_mul_f32 v54, v243, v54
    v_mul_f32 v55, v243, v55
    s_waitcnt lgkmcnt(0)
    v_fmac_f32 v32, v240, v176
    v_fmac_f32 v33, v240, v177
    v_fmac_f32 v34, v240, v178
    v_fmac_f32 v35, v240, v179
    v_cvt_pk_bf16_f32 v200, v32, v33
    v_cvt_pk_bf16_f32 v201, v34, v35
    ds_write_b64 v114, v[200:201] offset:1280
    v_fmac_f32 v36, v240, v180
    v_fmac_f32 v37, v240, v181
    v_fmac_f32 v38, v240, v182
    v_fmac_f32 v39, v240, v183
    v_cvt_pk_bf16_f32 v202, v36, v37
    v_cvt_pk_bf16_f32 v203, v38, v39
    ds_write_b64 v115, v[202:203] offset:1280
    v_fmac_f32 v40, v240, v184
    v_fmac_f32 v41, v240, v185
    v_fmac_f32 v42, v240, v186
    v_fmac_f32 v43, v240, v187
    v_cvt_pk_bf16_f32 v204, v40, v41
    v_cvt_pk_bf16_f32 v205, v42, v43
    ds_write_b64 v116, v[204:205] offset:1280
    v_fmac_f32 v44, v242, v176
    v_fmac_f32 v45, v242, v177
    v_fmac_f32 v46, v242, v178
    v_fmac_f32 v47, v242, v179
    v_cvt_pk_bf16_f32 v206, v44, v45
    v_cvt_pk_bf16_f32 v207, v46, v47
    ds_write_b64 v114, v[206:207] offset:2560
    v_fmac_f32 v48, v242, v180
    v_fmac_f32 v49, v242, v181
    v_fmac_f32 v50, v242, v182
    v_fmac_f32 v51, v242, v183
    v_cvt_pk_bf16_f32 v208, v48, v49
    v_cvt_pk_bf16_f32 v209, v50, v51
    ds_write_b64 v115, v[208:209] offset:2560
    v_fmac_f32 v52, v242, v184
    v_fmac_f32 v53, v242, v185
    v_fmac_f32 v54, v242, v186
    v_fmac_f32 v55, v242, v187
    v_cvt_pk_bf16_f32 v210, v52, v53
    v_cvt_pk_bf16_f32 v211, v54, v55
    ds_write_b64 v116, v[210:211] offset:2560
    v_mul_f32 v56, v245, v56
    v_mul_f32 v57, v245, v57
    v_mul_f32 v58, v245, v58
    v_mul_f32 v59, v245, v59
    v_fmac_f32 v56, v244, v176
    v_fmac_f32 v57, v244, v177
    v_fmac_f32 v58, v244, v178
    v_fmac_f32 v59, v244, v179
    v_cvt_pk_bf16_f32 v212, v56, v57
    v_cvt_pk_bf16_f32 v213, v58, v59
    ds_write_b64 v117, v[212:213] offset:1280
    v_mul_f32 v60, v245, v60
    v_mul_f32 v61, v245, v61
    v_mul_f32 v62, v245, v62
    v_mul_f32 v63, v245, v63
    v_fmac_f32 v60, v244, v180
    v_fmac_f32 v61, v244, v181
    v_fmac_f32 v62, v244, v182
    v_fmac_f32 v63, v244, v183
    v_cvt_pk_bf16_f32 v214, v60, v61
    v_cvt_pk_bf16_f32 v215, v62, v63
    ds_write_b64 v118, v[214:215] offset:1280
    v_mul_f32 v64, v245, v64
    v_mul_f32 v65, v245, v65
    v_mul_f32 v66, v245, v66
    v_mul_f32 v67, v245, v67
    v_fmac_f32 v64, v244, v184
    v_fmac_f32 v65, v244, v185
    v_fmac_f32 v66, v244, v186
    v_fmac_f32 v67, v244, v187
    v_cvt_pk_bf16_f32 v216, v64, v65
    v_cvt_pk_bf16_f32 v217, v66, v67
    ds_write_b64 v119, v[216:217] offset:1280
    v_mul_f32 v68, v247, v68
    v_mul_f32 v69, v247, v69
    v_mul_f32 v70, v247, v70
    v_mul_f32 v71, v247, v71
    v_fmac_f32 v68, v246, v176
    v_fmac_f32 v69, v246, v177
    v_fmac_f32 v70, v246, v178
    v_fmac_f32 v71, v246, v179
    v_cvt_pk_bf16_f32 v218, v68, v69
    v_cvt_pk_bf16_f32 v219, v70, v71
    ds_write_b64 v117, v[218:219] offset:2560
    v_mul_f32 v72, v247, v72
    v_mul_f32 v73, v247, v73
    v_mul_f32 v74, v247, v74
    v_mul_f32 v75, v247, v75
    v_fmac_f32 v72, v246, v180
    v_fmac_f32 v73, v246, v181
    v_fmac_f32 v74, v246, v182
    v_fmac_f32 v75, v246, v183
    v_cvt_pk_bf16_f32 v220, v72, v73
    v_cvt_pk_bf16_f32 v221, v74, v75
    ds_write_b64 v118, v[220:221] offset:2560
    v_mul_f32 v76, v247, v76
    v_mul_f32 v77, v247, v77
    v_mul_f32 v78, v247, v78
    v_mul_f32 v79, v247, v79
    v_fmac_f32 v76, v246, v184
    v_fmac_f32 v77, v246, v185
    v_fmac_f32 v78, v246, v186
    v_fmac_f32 v79, v246, v187
    v_cvt_pk_bf16_f32 v222, v76, v77
    v_cvt_pk_bf16_f32 v223, v78, v79
    ds_write_b64 v119, v[222:223] offset:2560
L_p1J_2:
    s_setprio 0
    s_waitcnt lgkmcnt(0)
    s_barrier
    ds_read_b128 v[48:51], v122 offset:1280
    ds_read_b128 v[56:59], v122 offset:21760
    ds_read_b128 v[60:63], v122 offset:23040
    ds_read_b128 v[52:55], v122 offset:2560
    ds_read_b128 v[64:67], v122 offset:24320
    ds_read_b64_tr_b16 v[68:69], v123 offset:43520
    ds_read_b64_tr_b16 v[70:71], v123 offset:44800
    ds_read_b64_tr_b16 v[72:73], v123 offset:46080
    ds_read_b64_tr_b16 v[74:75], v123 offset:43552
    ds_read_b64_tr_b16 v[76:77], v123 offset:44832
    ds_read_b64_tr_b16 v[78:79], v123 offset:46112
    s_waitcnt lgkmcnt(9)
    v_mfma_f32_16x16x32_bf16 v[32:35], v[56:59], v[48:51], v[96:99]
    s_waitcnt lgkmcnt(8)
    v_mfma_f32_16x16x32_bf16 v[36:39], v[60:63], v[48:51], v[104:107]
    s_waitcnt lgkmcnt(7)
    v_mfma_f32_16x16x32_bf16 v[40:43], v[60:63], v[52:55], v[100:103]
    s_waitcnt lgkmcnt(6)
    v_mfma_f32_16x16x32_bf16 v[44:47], v[64:67], v[52:55], v[104:107]
    s_and_b32 s96, s53, 0xfffffff0
    s_or_b32 s97, s96, s101
    s_mov_b32 s78, 0
    s_mov_b64 exec, 0xffffffff
    s_waitcnt vmcnt(7)
L_hel_3:
    v_and_b32 v4, 0xfffffff0, v14
    v_cmp_ne_u32 vcc, s96, v4
    v_cmp_ne_u32 s[88:89], s97, v14
    s_nop 0
    s_cbranch_vccnz L_helre_4
L_helback_5:
    s_mov_b64 exec, -1
    s_cmp_eq_u64 s[88:89], 0
    s_cselect_b32 s7, 1, 0
    v_max_f32 v32, v32, v33
    v_max_f32 v40, v40, v41
    v_max_f32 v34, v34, v35
    v_max_f32 v42, v42, v43
    v_max_f32 v36, v36, v37
    v_max_f32 v44, v44, v45
    v_max_f32 v38, v38, v39
    v_max_f32 v46, v46, v47
    v_max3_f32 v126, v32, v34, v36
    v_max3_f32 v130, v40, v42, v44
    v_max_f32 v126, v126, v38
    v_max_f32 v130, v130, v46
    v_mov_b32 v127, v126
    v_mov_b32 v131, v130
    s_nop 0
    v_permlane32_swap_b32 v126, v127
    v_permlane32_swap_b32 v130, v131
    v_max_f32 v126, v126, v127
    v_max_f32 v130, v130, v131
    v_mov_b32 v127, v126
    v_mov_b32 v131, v130
    s_nop 0
    v_permlane16_swap_b32 v126, v127
    v_permlane16_swap_b32 v130, v131
    v_max_f32 v126, v126, v127
    v_max_f32 v130, v130, v131
    v_mul_f32 v126, s62, v126
    v_mul_f32 v130, s62, v130
    v_fma_f32 v32, v32, s62, -v126
    v_fma_f32 v40, v40, s62, -v130
    v_fma_f32 v34, v34, s62, -v126
    v_fma_f32 v42, v42, s62, -v130
    v_fma_f32 v36, v36, s62, -v126
    v_fma_f32 v44, v44, s62, -v130
    v_fma_f32 v38, v38, s62, -v126
    v_fma_f32 v46, v46, s62, -v130
    v_exp_f32 v32, v32
    v_exp_f32 v40, v40
    v_exp_f32 v34, v34
    v_exp_f32 v42, v42
    v_exp_f32 v36, v36
    v_exp_f32 v44, v44
    v_exp_f32 v38, v38
    v_exp_f32 v46, v46
    v_add_f32 v126, v32, v34
    v_add_f32 v130, v40, v42
    v_add_f32 v127, v36, v38
    v_add_f32 v131, v44, v46
    v_add_f32 v126, v126, v127
    v_add_f32 v130, v130, v131
    v_mov_b32 v127, v126
    v_mov_b32 v131, v130
    s_nop 0
    v_permlane32_swap_b32 v126, v127
    v_permlane32_swap_b32 v130, v131
    v_add_f32 v126, v126, v127
    v_add_f32 v130, v130, v131
    v_mov_b32 v127, v126
    v_mov_b32 v131, v130
    s_nop 0
    v_permlane16_swap_b32 v126, v127
    v_permlane16_swap_b32 v130, v131
    v_add_f32 v126, v126, v127
    v_add_f32 v130, v130, v131
    v_rcp_f32 v126, v126
    v_rcp_f32 v130, v130
    v_mul_f32 v32, v126, v32
    v_mul_f32 v40, v130, v40
    v_mul_f32 v34, v126, v34
    v_mul_f32 v42, v130, v42
    v_mul_f32 v36, v126, v36
    v_mul_f32 v44, v130, v44
    v_mul_f32 v38, v126, v38
    v_mul_f32 v46, v130, v46
    v_cvt_pk_bf16_f32 v48, v32, 0
    v_cvt_pk_bf16_f32 v52, v40, 0
    v_cvt_pk_bf16_f32 v49, v34, 0
    v_cvt_pk_bf16_f32 v53, v42, 0
    v_cvt_pk_bf16_f32 v50, v36, 0
    v_cvt_pk_bf16_f32 v54, v44, 0
    v_cvt_pk_bf16_f32 v51, v38, 0
    v_cvt_pk_bf16_f32 v55, v46, 0
    v_lshlrev_b32 v48, v135, v48
    v_lshlrev_b32 v52, v135, v52
    v_lshlrev_b32 v49, v135, v49
    v_lshlrev_b32 v53, v135, v53
    v_lshlrev_b32 v50, v135, v50
    v_lshlrev_b32 v54, v135, v54
    v_lshlrev_b32 v51, v135, v51
    v_lshlrev_b32 v55, v135, v55
    s_waitcnt lgkmcnt(0)
    v_mfma_f32_16x16x32_bf16 v[32:35], v[68:71], v[48:51], 0
    v_mfma_f32_16x16x32_bf16 v[36:39], v[74:77], v[48:51], 0
    v_mfma_f32_16x16x32_bf16 v[40:43], v[70:73], v[52:55], 0
    v_mfma_f32_16x16x32_bf16 v[44:47], v[76:79], v[52:55], 0
    s_nop 4
    v_cvt_pk_bf16_f32 v56, v32, v33
    v_cvt_pk_bf16_f32 v57, v34, v35
    v_cvt_pk_bf16_f32 v58, v36, v37
    v_cvt_pk_bf16_f32 v59, v38, v39
    s_cmp_eq_u32 s7, 0
    s_cbranch_scc1 L_slow_6
    buffer_store_dwordx4 v[56:59], v16, s[36:39], s84 offen
L_back_7:
    v_cvt_pk_bf16_f32 v60, v40, v41
    v_cvt_pk_bf16_f32 v61, v42, v43
    v_cvt_pk_bf16_f32 v62, v44, v45
    v_cvt_pk_bf16_f32 v63, v46, v47
    s_cmp_eq_u32 s7, 0
    s_cbranch_scc1 L_slow_8
    buffer_store_dwordx4 v[60:63], v16, s[36:39], s87 offen
L_back_9:
    v_mov_b32 v4, s53
    v_mov_b32 v5, 0
    s_waitcnt vmcnt(0)
    s_mov_b64 exec, 1
    s_cmp_eq_u32 s7, 0
    s_cbranch_scc1 L_slow_10
    buffer_store_dword v4, v5, s[36:39], s85 offen
L_back_11:
    s_mov_b64 exec, -1
    s_cmp_ge_u32 s6, 14
    s_cbranch_scc1 L_spare
    s_barrier
    s_add_u32 m0, s58, 0
    s_mov_b32 s96, 0
    buffer_load_dwordx4 v28, s[20:23], s96 offen lds
    s_add_u32 m0, s58, 8192
    s_mov_b32 s96, 229376
    buffer_load_dwordx4 v28, s[20:23], s96 offen lds
    s_add_u32 m0, s58, 16384
    s_mov_b32 s96, 458752
    buffer_load_dwordx4 v28, s[20:23], s96 offen lds
    s_add_u32 m0, s58, 24576
    s_mov_b32 s96, 688128
    buffer_load_dwordx4 v28, s[20:23], s96 offen lds
    s_add_u32 m0, s58, 32768
    s_mov_b32 s96, 917504
    buffer_load_dwordx4 v28, s[20:23], s96 offen lds
    s_add_u32 m0, s58, 40960
    s_mov_b32 s96, 1146880
    buffer_load_dwordx4 v28, s[20:23], s96 offen lds
    s_add_u32 m0, s58, 49152
    s_mov_b32 s96, 1376256
    buffer_load_dwordx4 v28, s[20:23], s96 offen lds
    v_lshrrev_b32 v4, 3, v2
    v_lshrrev_b32 v5, 5, v1
    v_lshl_add_u32 v4, v5, 1, v4
    v_and_b32 v5, 1, v3
    v_lshl_add_u32 v4, v4, 1, v5
    v_mul_u32_u24 v4, 3584, v4
    v_and_b32 v6, 7, v1
    v_lshl_add_u32 v15, v6, 4, v4
    s_mul_i32 s59, s4, 200704
    s_lshl_b32 s96, s52, 7
    s_add_u32 s59, s59, s96
    s_add_u32 s98, s59, 0
    buffer_load_dwordx4 v[32:35], v15, s[28:31], s98 offen offset:0
    buffer_load_dwordx4 v[36:39], v15, s[28:31], s98 offen offset:896
    buffer_load_dwordx4 v[40:43], v15, s[28:31], s98 offen offset:1792
    buffer_load_dwordx4 v[44:47], v15, s[28:31], s98 offen offset:2688
    v_bfe_u32 v4, v1, 2, 2
    v_and_b32 v7, 3, v1
    v_lshl_add_u32 v5, v3, 2, v4
    v_bfe_u32 v6, v5, 1, 2
    s_lshl_b32 s60, s45, 1
    s_xor_b32 s60, s60, s44
    v_xor_b32 v6, s60, v6
    v_lshlrev_b32 v5, 7, v5
    v_lshl_add_u32 v5, v6, 5, v5
    v_lshl_add_u32 v5, v7, 3, v5
    s_mul_i32 s60, s45, 75904
    v_add_u32 v5, s60, v5
    s_lshl_b32 s60, s4, 6
    s_add_u32 s60, s60, 159232
    v_lshl_add_u32 v6, v3, 4, s60
    v_mov_b32 v220, 0x3f803f80
    v_mov_b32 v221, 0x3f803f80
    v_mov_b32 v222, 0x3f803f80
    v_mov_b32 v223, 0x3f803f80
    s_waitcnt vmcnt(4)
    s_barrier
    ds_read_b64_tr_b16 v[160:161], v5 offset:0
    ds_read_b64_tr_b16 v[162:163], v5 offset:2048
    ds_read_b64_tr_b16 v[164:165], v5 offset:4096
    ds_read_b64_tr_b16 v[166:167], v5 offset:6144
    ds_read_b64_tr_b16 v[168:169], v5 offset:8192
    ds_read_b64_tr_b16 v[170:171], v5 offset:10240
    ds_read_b64_tr_b16 v[172:173], v5 offset:12288
    ds_read_b64_tr_b16 v[174:175], v5 offset:14336
    ds_read_b64_tr_b16 v[176:177], v5 offset:16384
    ds_read_b64_tr_b16 v[178:179], v5 offset:18432
    ds_read_b64_tr_b16 v[180:181], v5 offset:20480
    ds_read_b64_tr_b16 v[182:183], v5 offset:22528
    ds_read_b64_tr_b16 v[184:185], v5 offset:24576
    ds_read_b64_tr_b16 v[186:187], v5 offset:26624
    ds_read_b64_tr_b16 v[188:189], v5 offset:28672
    ds_read_b64_tr_b16 v[190:191], v5 offset:30720
    ds_read_b64_tr_b16 v[192:193], v5 offset:32768
    ds_read_b64_tr_b16 v[194:195], v5 offset:34816
    ds_read_b64_tr_b16 v[196:197], v5 offset:36864
    ds_read_b64_tr_b16 v[198:199], v5 offset:38912
    ds_read_b64_tr_b16 v[200:201], v5 offset:40960
    ds_read_b64_tr_b16 v[202:203], v5 offset:43008
    ds_read_b64_tr_b16 v[204:205], v5 offset:45056
    ds_read_b64_tr_b16 v[206:207], v5 offset:47104
    ds_read_b64_tr_b16 v[208:209], v5 offset:49152
    ds_read_b64_tr_b16 v[210:211], v5 offset:51200
    ds_read_b64_tr_b16 v[212:213], v5 offset:53248
    ds_read_b64_tr_b16 v[214:215], v5 offset:55296
    s_waitcnt lgkmcnt(15)
    v_mfma_f32_16x16x32_bf16 v[216:219], v[160:163], v[220:223], 0
    s_waitcnt lgkmcnt(15)
    v_mfma_f32_16x16x32_bf16 v[216:219], v[164:167], v[220:223], v[216:219]
    s_waitcnt lgkmcnt(15)
    v_mfma_f32_16x16x32_bf16 v[216:219], v[168:171], v[220:223], v[216:219]
    s_waitcnt lgkmcnt(15)
    v_mfma_f32_16x16x32_bf16 v[216:219], v[172:175], v[220:223], v[216:219]
    s_waitcnt lgkmcnt(15)
    v_mfma_f32_16x16x32_bf16 v[216:219], v[176:179], v[220:223], v[216:219]
    s_waitcnt lgkmcnt(15)
    v_mfma_f32_16x16x32_bf16 v[216:219], v[180:183], v[220:223], v[216:219]
    s_waitcnt lgkmcnt(14)
    v_mfma_f32_16x16x32_bf16 v[216:219], v[184:187], v[220:223], v[216:219]
    s_waitcnt lgkmcnt(12)
    v_mfma_f32_16x16x32_bf16 v[216:219], v[188:191], v[220:223], v[216:219]
    s_waitcnt lgkmcnt(10)
    v_mfma_f32_16x16x32_bf16 v[216:219], v[192:195], v[220:223], v[216:219]
    s_waitcnt lgkmcnt(8)
    v_mfma_f32_16x16x32_bf16 v[216:219], v[196:199], v[220:223], v[216:219]
    s_waitcnt lgkmcnt(6)
    v_mfma_f32_16x16x32_bf16 v[216:219], v[200:203], v[220:223], v[216:219]
    s_waitcnt lgkmcnt(4)
    v_mfma_f32_16x16x32_bf16 v[216:219], v[204:207], v[220:223], v[216:219]
    s_waitcnt lgkmcnt(2)
    v_mfma_f32_16x16x32_bf16 v[216:219], v[208:211], v[220:223], v[216:219]
    s_waitcnt lgkmcnt(0)
    v_mfma_f32_16x16x32_bf16 v[216:219], v[212:215], v[220:223], v[216:219]
    s_mov_b64 exec, s[66:67]
    s_nop 6
    ds_write_b128 v6, v[216:219]
    v_mov_b32 v4, 162816
    v_mov_b32 v7, 0
    ds_write_b32 v4, v7
    s_mov_b64 exec, -1
    s_waitcnt lgkmcnt(0)
    s_barrier
    v_bfe_u32 v4, v1, 2, 2
    v_lshrrev_b32 v8, 5, v1
    v_lshl_add_u32 v5, v8, 2, v4
    v_lshrrev_b32 v6, 1, v5
    v_and_b32 v9, 1, v3
    v_lshlrev_b32 v7, 1, v9
    v_xor_b32 v6, v6, v7
    v_lshlrev_b32 v5, 7, v5
    v_lshl_add_u32 v5, v6, 5, v5
    v_and_b32 v7, 3, v1
    v_lshl_add_u32 v5, v7, 3, v5
    v_mul_u32_u24 v6, 75904, v9
    v_add_u32 v6, 0, v6
    v_xor_b32 v10, 0, v5
    v_add_u32 v17, v6, v10
    v_xor_b32 v10, 32, v5
    v_add_u32 v18, v6, v10
    v_xor_b32 v10, 64, v5
    v_add_u32 v19, v6, v10
    v_xor_b32 v10, 96, v5
    v_add_u32 v20, v6, v10
    v_lshlrev_b32 v4, 4, v2
    v_lshl_add_u32 v4, v8, 8, v4
    v_mul_u32_u24 v6, 57344, v9
    v_add_u32 v22, v4, v6
    v_mul_u32_u24 v6, 1792, v9
    v_add_u32 v21, v4, v6
    v_lshlrev_b32 v23, 4, v8
    v_add_u32 v23, 159232, v23
    s_mov_b32 s65, s4
    s_lshl_b32 s64, s5, 3
    s_add_u32 s64, s64, s65
    s_mul_i32 s84, s64, 114688
    s_lshl_b32 s61, s49, 11
    s_add_u32 s84, s84, s61
    s_add_u32 s84, s84, 2097152
    s_lshl_b32 s61, s65, 5
    s_add_u32 s61, s61, s49
    s_lshl_b32 s61, s61, 2
    s_add_u32 s61, s61, s54
    s_add_u32 s85, s61, 3072
    s_lshl_b32 s61, s65, 6
    s_add_u32 s61, s61, s54
    s_add_u32 s62, s61, 2048
    s_mul_i32 s60, s64, 28672
    s_mul_i32 s63, s64, 3584
    s_add_u32 s63, s63, 1835008
    s_branch L_p3
L_roleb:
    s_load_dwordx2 s[16:17], s[0:1], 16
    s_load_dwordx2 s[20:21], s[0:1], 32
    s_load_dwordx2 s[24:25], s[0:1], 40
    s_load_dwordx2 s[28:29], s[0:1], 48
    s_load_dwordx2 s[32:33], s[0:1], 56
    v_and_b32 v2, 15, v1
    s_lshr_b32 s44, s4, 1
    v_cmp_eq_u32 s[66:67], 0, v2
    v_lshlrev_b32 v15, 7, v1
    s_sub_u32 s98, s6, 16
    s_lshl_b32 s98, s98, 3
    s_add_u32 s98, s98, s4
    v_mov_b32 v5, 0
    s_waitcnt lgkmcnt(0)
    s_mov_b32 s12, s10
    s_mov_b32 s13, s11
    s_mov_b32 s10, 1835008
    s_mov_b32 s11, 0x00020000
    buffer_load_dword v14, v5, s[36:39], s54 offen sc1
    s_mul_i32 s97, s5, 229376
    s_mul_i32 s96, s98, 1792
    s_add_u32 s96, s96, s97
    s_bfm_b64 exec, 14, 0
    buffer_load_dword v31, v15, s[8:11], s96 offen
    s_mov_b64 exec, -1
    s_mul_i32 s96, s98, 4736
    s_bfm_b64 exec, 37, 0
    buffer_load_dword v31, v15, s[12:15], s96 offen
    s_mov_b64 exec, -1
    s_mul_i32 s96, s98, 4736
    s_add_u32 s96, s96, 606208
    s_bfm_b64 exec, 37, 0
    buffer_load_dword v31, v15, s[12:15], s96 offen
    s_mov_b64 exec, -1
    s_mov_b32 s18, 401408
    s_mov_b32 s19, 0x00020000
    s_mov_b32 s22, 1605632
    s_mov_b32 s23, 0x00020000
    s_mov_b32 s26, 1605632
    s_mov_b32 s27, 0x00020000
    s_mov_b32 s30, 1605632
    s_mov_b32 s31, 0x00020000
    s_mov_b32 s34, 1835008
    s_mov_b32 s35, 0x00020000
    v_lshlrev_b32 v16, 4, v1
    v_cmp_eq_u32 s[68:69], 3, v3
    s_lshr_b32 s46, s4, 2
    s_cmp_ge_u32 s6, 16
    s_cselect_b32 s60, 2, 0
    s_sub_u32 s49, s6, s60
    s_mul_i32 s51, s49, 37
    s_lshr_b32 s51, s51, 8
    s_mul_i32 s60, s51, 7
    s_sub_u32 s52, s49, s60
    s_lshl_b32 s58, s4, 10
    v_lshlrev_b32 v5, 1, v3
    v_and_b32 v6, 7, v1
    v_xor_b32 v5, v5, v6
    v_lshrrev_b32 v4, 3, v1
    v_mul_u32_u24 v7, 3584, v4
    v_lshl_add_u32 v7, v5, 4, v7
    s_mul_i32 s60, s4, 28672
    s_lshl_b32 s61, s49, 7
    s_add_u32 s60, s60, s61
    v_add_u32 v28, s60, v7
    v_xor_b32 v29, 64, v28
    s_getreg_b32 s101, hwreg(HW_REG_XCC_ID)
    s_and_b32 s101, s101, 15
    v_lshrrev_b32 v4, 3, v1
    v_lshlrev_b32 v4, 7, v4
    v_and_b32 v5, 7, v1
    v_lshl_add_u32 v30, v5, 2, v4
    v_add_u32 v30, 128, v30
    s_waitcnt vmcnt(3)
    v_readfirstlane_b32 s55, v14
    s_nop 0
    s_add_u32 s53, s55, 1
    s_mul_i32 s53, s53, 0x9E3779B1
    s_xor_b32 s53, s53, 0x5bd1e995
    s_and_b32 s96, s53, 0xfffffff0
    s_or_b32 s96, s96, s101
    v_mov_b32 v8, s96
    s_lshl_b64 exec, 1, s6
    s_cmp_eq_u32 s4, 0
    s_cselect_b64 exec, exec, 0
    buffer_store_dword v8, v30, s[36:39], s54 offen sc1
    s_mov_b64 exec, -1
    s_cmp_ge_u32 s6, 30
    s_cbranch_scc1 L_rolec
    v_lshrrev_b32 v4, 3, v1
    v_mul_u32_u24 v4, 896, v4
    v_lshlrev_b32 v5, 1, v3
    v_and_b32 v6, 7, v1
    v_xor_b32 v5, v5, v6
    v_lshl_add_u32 v4, v5, 4, v4
    s_mul_i32 s60, s4, 7168
    s_lshl_b32 s61, s52, 7
    s_add_u32 s60, s60, s61
    v_add_u32 v9, s60, v4
    s_add_u32 s96, s5, 0
    s_and_b32 s96, s96, 7
    s_lshl_b32 s97, s96, 13
    s_add_u32 m0, s97, s58
    s_mul_i32 s96, s96, 57344
    buffer_load_dwordx4 v9, s[16:19], s96 offen lds
    s_add_u32 s96, s5, 1
    s_and_b32 s96, s96, 7
    s_lshl_b32 s97, s96, 13
    s_add_u32 m0, s97, s58
    s_mul_i32 s96, s96, 57344
    buffer_load_dwordx4 v9, s[16:19], s96 offen lds
    s_add_u32 s96, s5, 2
    s_and_b32 s96, s96, 7
    s_lshl_b32 s97, s96, 13
    s_add_u32 m0, s97, s58
    s_mul_i32 s96, s96, 57344
    buffer_load_dwordx4 v9, s[16:19], s96 offen lds
    s_add_u32 s96, s5, 3
    s_and_b32 s96, s96, 7
    s_lshl_b32 s97, s96, 13
    s_add_u32 m0, s97, s58
    s_mul_i32 s96, s96, 57344
    buffer_load_dwordx4 v9, s[16:19], s96 offen lds
    s_add_u32 s96, s5, 4
    s_and_b32 s96, s96, 7
    s_lshl_b32 s97, s96, 13
    s_add_u32 m0, s97, s58
    s_mul_i32 s96, s96, 57344
    buffer_load_dwordx4 v9, s[16:19], s96 offen lds
    s_add_u32 s96, s5, 5
    s_and_b32 s96, s96, 7
    s_lshl_b32 s97, s96, 13
    s_add_u32 m0, s97, s58
    s_mul_i32 s96, s96, 57344
    buffer_load_dwordx4 v9, s[16:19], s96 offen lds
    s_add_u32 s96, s5, 6
    s_and_b32 s96, s96, 7
    s_lshl_b32 s97, s96, 13
    s_add_u32 m0, s97, s58
    s_mul_i32 s96, s96, 57344
    buffer_load_dwordx4 v9, s[16:19], s96 offen lds
    s_add_u32 s96, s5, 7
    s_and_b32 s96, s96, 7
    s_lshl_b32 s97, s96, 13
    s_add_u32 m0, s97, s58
    s_mul_i32 s96, s96, 57344
    buffer_load_dwordx4 v9, s[16:19], s96 offen lds
    s_add_u32 s96, s5, 0
    s_cmp_ge_u32 s96, 7
    s_cselect_b32 s97, 7, 0
    s_sub_u32 s96, s96, s97
    s_lshl_b32 s97, s96, 13
    s_add_u32 s97, s97, s58
    s_add_u32 m0, s97, 75904
    s_mul_i32 s96, s96, 229376
    buffer_load_dwordx4 v29, s[24:27], s96 offen lds
    s_add_u32 s96, s5, 1
    s_cmp_ge_u32 s96, 7
    s_cselect_b32 s97, 7, 0
    s_sub_u32 s96, s96, s97
    s_lshl_b32 s97, s96, 13
    s_add_u32 s97, s97, s58
    s_add_u32 m0, s97, 75904
    s_mul_i32 s96, s96, 229376
    buffer_load_dwordx4 v29, s[24:27], s96 offen lds
    s_add_u32 s96, s5, 2
    s_cmp_ge_u32 s96, 7
    s_cselect_b32 s97, 7, 0
    s_sub_u32 s96, s96, s97
    s_lshl_b32 s97, s96, 13
    s_add_u32 s97, s97, s58
    s_add_u32 m0, s97, 75904
    s_mul_i32 s96, s96, 229376
    buffer_load_dwordx4 v29, s[24:27], s96 offen lds
    s_add_u32 s96, s5, 3
    s_cmp_ge_u32 s96, 7
    s_cselect_b32 s97, 7, 0
    s_sub_u32 s96, s96, s97
    s_lshl_b32 s97, s96, 13
    s_add_u32 s97, s97, s58
    s_add_u32 m0, s97, 75904
    s_mul_i32 s96, s96, 229376
    buffer_load_dwordx4 v29, s[24:27], s96 offen lds
    s_add_u32 s96, s5, 4
    s_cmp_ge_u32 s96, 7
    s_cselect_b32 s97, 7, 0
    s_sub_u32 s96, s96, s97
    s_lshl_b32 s97, s96, 13
    s_add_u32 s97, s97, s58
    s_add_u32 m0, s97, 75904
    s_mul_i32 s96, s96, 229376
    buffer_load_dwordx4 v29, s[24:27], s96 offen lds
    s_add_u32 s96, s5, 5
    s_cmp_ge_u32 s96, 7
    s_cselect_b32 s97, 7, 0
    s_sub_u32 s96, s96, s97
    s_lshl_b32 s97, s96, 13
    s_add_u32 s97, s97, s58
    s_add_u32 m0, s97, 75904
    s_mul_i32 s96, s96, 229376
    buffer_load_dwordx4 v29, s[24:27], s96 offen lds
    s_add_u32 s96, s5, 6
    s_cmp_ge_u32 s96, 7
    s_cselect_b32 s97, 7, 0
    s_sub_u32 s96, s96, s97
    s_lshl_b32 s97, s96, 13
    s_add_u32 s97, s97, s58
    s_add_u32 m0, s97, 75904
    s_mul_i32 s96, s96, 229376
    buffer_load_dwordx4 v29, s[24:27], s96 offen lds
    s_sub_u32 s60, s51, 2
    s_lshl_b32 s60, s60, 2
    s_and_b32 s61, s4, 3
    s_add_u32 s65, s60, s61
    s_lshl_b32 s60, s5, 3
    s_add_u32 s86, s60, s65
    s_mul_i32 s60, s86, 28672
    s_lshl_b32 s61, s52, 7
    s_add_u32 s60, s60, s61
    s_lshl_b32 s61, s46, 6
    s_add_u32 s60, s60, s61
    s_add_u32 s61, s60, 14336
    v_mul_u32_u24 v4, 896, v2
    v_lshl_add_u32 v4, v3, 3, v4
    buffer_load_dwordx2 v[20:21], v4, s[8:11], s60 offen offset:0
    buffer_load_dwordx2 v[22:23], v4, s[8:11], s60 offen offset:32
    buffer_load_dwordx2 v[24:25], v4, s[8:11], s61 offen offset:0
    buffer_load_dwordx2 v[26:27], v4, s[8:11], s61 offen offset:32
    v_bfe_u32 v6, v1, 2, 2
    v_lshl_add_u32 v8, v3, 2, v6
    v_bfe_u32 v6, v8, 1, 2
    s_lshl_b32 s61, s46, 1
    v_xor_b32 v6, s61, v6
    v_lshlrev_b32 v8, 7, v8
    v_lshl_add_u32 v8, v6, 5, v8
    v_and_b32 v7, 3, v1
    v_lshl_add_u32 v8, v7, 3, v8
    s_mul_i32 s61, s46, 28672
    v_xor_b32 v7, 0, v8
    v_add_u32 v10, s61, v7
    v_xor_b32 v7, 32, v8
    v_add_u32 v11, s61, v7
    v_xor_b32 v7, 64, v8
    v_add_u32 v12, s61, v7
    v_xor_b32 v7, 96, v8
    v_add_u32 v13, s61, v7
    s_waitcnt vmcnt(11)
    s_barrier
    ds_read_b64_tr_b16 v[32:33], v10 offset:0
    ds_read_b64_tr_b16 v[34:35], v10 offset:2048
    ds_read_b64_tr_b16 v[36:37], v11 offset:0
    ds_read_b64_tr_b16 v[38:39], v11 offset:2048
    ds_read_b64_tr_b16 v[40:41], v12 offset:0
    ds_read_b64_tr_b16 v[42:43], v12 offset:2048
    ds_read_b64_tr_b16 v[44:45], v13 offset:0
    ds_read_b64_tr_b16 v[46:47], v13 offset:2048
    ds_read_b64_tr_b16 v[48:49], v12 offset:3584
    ds_read_b64_tr_b16 v[50:51], v12 offset:5632
    ds_read_b64_tr_b16 v[52:53], v13 offset:3584
    ds_read_b64_tr_b16 v[54:55], v13 offset:5632
    ds_read_b64_tr_b16 v[56:57], v10 offset:3584
    ds_read_b64_tr_b16 v[58:59], v10 offset:5632
    ds_read_b64_tr_b16 v[60:61], v11 offset:3584
    ds_read_b64_tr_b16 v[62:63], v11 offset:5632
    ds_read_b64_tr_b16 v[64:65], v10 offset:7168
    ds_read_b64_tr_b16 v[66:67], v10 offset:9216
    ds_read_b64_tr_b16 v[68:69], v11 offset:7168
    ds_read_b64_tr_b16 v[70:71], v11 offset:9216
    ds_read_b64_tr_b16 v[72:73], v12 offset:7168
    ds_read_b64_tr_b16 v[74:75], v12 offset:9216
    ds_read_b64_tr_b16 v[76:77], v13 offset:7168
    ds_read_b64_tr_b16 v[78:79], v13 offset:9216
    ds_read_b64_tr_b16 v[80:81], v12 offset:10752
    ds_read_b64_tr_b16 v[82:83], v12 offset:12800
    ds_read_b64_tr_b16 v[84:85], v13 offset:10752
    ds_read_b64_tr_b16 v[86:87], v13 offset:12800
    ds_read_b64_tr_b16 v[88:89], v10 offset:10752
    ds_read_b64_tr_b16 v[90:91], v10 offset:12800
    ds_read_b64_tr_b16 v[92:93], v11 offset:10752
    ds_read_b64_tr_b16 v[94:95], v11 offset:12800
    ds_read_b64_tr_b16 v[96:97], v10 offset:14336
    ds_read_b64_tr_b16 v[98:99], v10 offset:16384
    ds_read_b64_tr_b16 v[100:101], v11 offset:14336
    ds_read_b64_tr_b16 v[102:103], v11 offset:16384
    ds_read_b64_tr_b16 v[104:105], v12 offset:14336
    ds_read_b64_tr_b16 v[106:107], v12 offset:16384
    ds_read_b64_tr_b16 v[108:109], v13 offset:14336
    ds_read_b64_tr_b16 v[110:111], v13 offset:16384
    ds_read_b64_tr_b16 v[112:113], v12 offset:17920
    ds_read_b64_tr_b16 v[114:115], v12 offset:19968
    ds_read_b64_tr_b16 v[116:117], v13 offset:17920
    ds_read_b64_tr_b16 v[118:119], v13 offset:19968
    ds_read_b64_tr_b16 v[120:121], v10 offset:17920
    ds_read_b64_tr_b16 v[122:123], v10 offset:19968
    ds_read_b64_tr_b16 v[124:125], v11 offset:17920
    ds_read_b64_tr_b16 v[126:127], v11 offset:19968
    ds_read_b64_tr_b16 v[128:129], v10 offset:21504
    ds_read_b64_tr_b16 v[130:131], v10 offset:23552
    ds_read_b64_tr_b16 v[132:133], v11 offset:21504
    ds_read_b64_tr_b16 v[134:135], v11 offset:23552
    ds_read_b64_tr_b16 v[136:137], v12 offset:21504
    ds_read_b64_tr_b16 v[138:139], v12 offset:23552
    ds_read_b64_tr_b16 v[140:141], v13 offset:21504
    ds_read_b64_tr_b16 v[142:143], v13 offset:23552
    ds_read_b64_tr_b16 v[144:145], v12 offset:25088
    ds_read_b64_tr_b16 v[146:147], v12 offset:27136
    ds_read_b64_tr_b16 v[148:149], v13 offset:25088
    ds_read_b64_tr_b16 v[150:151], v13 offset:27136
    ds_read_b64_tr_b16 v[152:153], v10 offset:25088
    ds_read_b64_tr_b16 v[154:155], v10 offset:27136
    ds_read_b64_tr_b16 v[156:157], v11 offset:25088
    ds_read_b64_tr_b16 v[158:159], v11 offset:27136
    s_waitcnt lgkmcnt(0)
    s_barrier
    s_add_u32 s96, s5, 0
    s_cmp_ge_u32 s96, 7
    s_cselect_b32 s97, 7, 0
    s_sub_u32 s96, s96, s97
    s_lshl_b32 s97, s96, 13
    s_add_u32 s97, s97, s58
    s_add_u32 m0, s97, 0
    s_mul_i32 s96, s96, 229376
    buffer_load_dwordx4 v28, s[20:23], s96 offen lds
    s_add_u32 s96, s5, 1
    s_cmp_ge_u32 s96, 7
    s_cselect_b32 s97, 7, 0
    s_sub_u32 s96, s96, s97
    s_lshl_b32 s97, s96, 13
    s_add_u32 s97, s97, s58
    s_add_u32 m0, s97, 0
    s_mul_i32 s96, s96, 229376
    buffer_load_dwordx4 v28, s[20:23], s96 offen lds
    s_add_u32 s96, s5, 2
    s_cmp_ge_u32 s96, 7
    s_cselect_b32 s97, 7, 0
    s_sub_u32 s96, s96, s97
    s_lshl_b32 s97, s96, 13
    s_add_u32 s97, s97, s58
    s_add_u32 m0, s97, 0
    s_mul_i32 s96, s96, 229376
    buffer_load_dwordx4 v28, s[20:23], s96 offen lds
    s_add_u32 s96, s5, 3
    s_cmp_ge_u32 s96, 7
    s_cselect_b32 s97, 7, 0
    s_sub_u32 s96, s96, s97
    s_lshl_b32 s97, s96, 13
    s_add_u32 s97, s97, s58
    s_add_u32 m0, s97, 0
    s_mul_i32 s96, s96, 229376
    buffer_load_dwordx4 v28, s[20:23], s96 offen lds
    s_add_u32 s96, s5, 4
    s_cmp_ge_u32 s96, 7
    s_cselect_b32 s97, 7, 0
    s_sub_u32 s96, s96, s97
    s_lshl_b32 s97, s96, 13
    s_add_u32 s97, s97, s58
    s_add_u32 m0, s97, 0
    s_mul_i32 s96, s96, 229376
    buffer_load_dwordx4 v28, s[20:23], s96 offen lds
    s_add_u32 s96, s5, 5
    s_cmp_ge_u32 s96, 7
    s_cselect_b32 s97, 7, 0
    s_sub_u32 s96, s96, s97
    s_lshl_b32 s97, s96, 13
    s_add_u32 s97, s97, s58
    s_add_u32 m0, s97, 0
    s_mul_i32 s96, s96, 229376
    buffer_load_dwordx4 v28, s[20:23], s96 offen lds
    s_add_u32 s96, s5, 6
    s_cmp_ge_u32 s96, 7
    s_cselect_b32 s97, 7, 0
    s_sub_u32 s96, s96, s97
    s_lshl_b32 s97, s96, 13
    s_add_u32 s97, s97, s58
    s_add_u32 m0, s97, 0
    s_mul_i32 s96, s96, 229376
    buffer_load_dwordx4 v28, s[20:23], s96 offen lds
    s_lshr_b32 s96, s98, 3
    s_lshl_b32 s97, s5, 4
    s_add_u32 s96, s96, s97
    s_mul_i32 s96, s96, 57344
    s_and_b32 s97, s98, 7
    s_lshl_b32 s97, s97, 11
    s_add_u32 s96, s96, s97
    s_add_u32 s96, s96, 2097152
    v_add_u32 v4, s96, v15
    s_lshl_b32 s97, s5, 7
    s_add_u32 s97, s97, s98
    s_mul_i32 s96, s97, 1792
    s_sub_u32 s96, s96, 2048
    v_add_u32 v5, s96, v15
    v_cmp_le_u32 vcc, 16, v1
    s_mul_i32 s96, s97, 224
    s_add_u32 s96, s96, 1831168
    v_cndmask_b32 v4, v4, v5, vcc
    v_add_u32 v5, s96, v15
    v_cmp_le_u32 vcc, 30, v1
    s_and_b32 s96, s98, 31
    s_lshl_b32 s96, s96, 7
    s_add_u32 s96, s96, s54
    s_add_u32 s96, s96, 1024
    v_cndmask_b32 v4, v4, v5, vcc
    v_mov_b32 v5, s96
    v_cmp_le_u32 vcc, 32, v1
    s_nop 1
    v_cndmask_b32 v4, v4, v5, vcc
    s_mov_b32 exec_lo, 0xffff0000
    s_mov_b32 exec_hi, 1
    buffer_load_dword v31, v4, s[36:39], 0 offen sc1
    s_mov_b64 exec, -1
    s_mov_b64 exec, 0xffffffff
    buffer_load_dword v14, v30, s[36:39], s54 offen sc1
    s_mov_b64 exec, -1
    v_bfe_u32 v4, v1, 2, 2
    v_and_b32 v7, 3, v1
    v_lshl_add_u32 v5, v3, 2, v4
    v_bfe_u32 v6, v5, 1, 2
    s_lshl_b32 s60, s45, 1
    s_xor_b32 s60, s60, s44
    v_xor_b32 v6, s60, v6
    v_lshlrev_b32 v5, 7, v5
    v_lshl_add_u32 v5, v6, 5, v5
    v_lshl_add_u32 v5, v7, 3, v5
    s_mul_i32 s60, s45, 75904
    v_add_u32 v5, s60, v5
    s_lshl_b32 s60, s4, 6
    s_add_u32 s60, s60, 159232
    v_lshl_add_u32 v6, v3, 4, s60
    v_mov_b32 v220, 0x3f803f80
    v_mov_b32 v221, 0x3f803f80
    v_mov_b32 v222, 0x3f803f80
    v_mov_b32 v223, 0x3f803f80
    s_waitcnt vmcnt(2)
    s_barrier
    ds_read_b64_tr_b16 v[160:161], v5 offset:0
    ds_read_b64_tr_b16 v[162:163], v5 offset:2048
    ds_read_b64_tr_b16 v[164:165], v5 offset:4096
    ds_read_b64_tr_b16 v[166:167], v5 offset:6144
    ds_read_b64_tr_b16 v[168:169], v5 offset:8192
    ds_read_b64_tr_b16 v[170:171], v5 offset:10240
    ds_read_b64_tr_b16 v[172:173], v5 offset:12288
    ds_read_b64_tr_b16 v[174:175], v5 offset:14336
    ds_read_b64_tr_b16 v[176:177], v5 offset:16384
    ds_read_b64_tr_b16 v[178:179], v5 offset:18432
    ds_read_b64_tr_b16 v[180:181], v5 offset:20480
    ds_read_b64_tr_b16 v[182:183], v5 offset:22528
    ds_read_b64_tr_b16 v[184:185], v5 offset:24576
    ds_read_b64_tr_b16 v[186:187], v5 offset:26624
    ds_read_b64_tr_b16 v[188:189], v5 offset:28672
    ds_read_b64_tr_b16 v[190:191], v5 offset:30720
    ds_read_b64_tr_b16 v[192:193], v5 offset:32768
    ds_read_b64_tr_b16 v[194:195], v5 offset:34816
    ds_read_b64_tr_b16 v[196:197], v5 offset:36864
    ds_read_b64_tr_b16 v[198:199], v5 offset:38912
    ds_read_b64_tr_b16 v[200:201], v5 offset:40960
    ds_read_b64_tr_b16 v[202:203], v5 offset:43008
    ds_read_b64_tr_b16 v[204:205], v5 offset:45056
    ds_read_b64_tr_b16 v[206:207], v5 offset:47104
    ds_read_b64_tr_b16 v[208:209], v5 offset:49152
    ds_read_b64_tr_b16 v[210:211], v5 offset:51200
    ds_read_b64_tr_b16 v[212:213], v5 offset:53248
    ds_read_b64_tr_b16 v[214:215], v5 offset:55296
    s_waitcnt lgkmcnt(15)
    v_mfma_f32_16x16x32_bf16 v[216:219], v[160:163], v[220:223], 0
    s_waitcnt lgkmcnt(15)
    v_mfma_f32_16x16x32_bf16 v[216:219], v[164:167], v[220:223], v[216:219]
    s_waitcnt lgkmcnt(15)
    v_mfma_f32_16x16x32_bf16 v[216:219], v[168:171], v[220:223], v[216:219]
    s_waitcnt lgkmcnt(15)
    v_mfma_f32_16x16x32_bf16 v[216:219], v[172:175], v[220:223], v[216:219]
    s_waitcnt lgkmcnt(15)
    v_mfma_f32_16x16x32_bf16 v[216:219], v[176:179], v[220:223], v[216:219]
    s_waitcnt lgkmcnt(15)
    v_mfma_f32_16x16x32_bf16 v[216:219], v[180:183], v[220:223], v[216:219]
    s_waitcnt lgkmcnt(14)
    v_mfma_f32_16x16x32_bf16 v[216:219], v[184:187], v[220:223], v[216:219]
    s_waitcnt lgkmcnt(12)
    v_mfma_f32_16x16x32_bf16 v[216:219], v[188:191], v[220:223], v[216:219]
    s_waitcnt lgkmcnt(10)
    v_mfma_f32_16x16x32_bf16 v[216:219], v[192:195], v[220:223], v[216:219]
    s_waitcnt lgkmcnt(8)
    v_mfma_f32_16x16x32_bf16 v[216:219], v[196:199], v[220:223], v[216:219]
    s_waitcnt lgkmcnt(6)
    v_mfma_f32_16x16x32_bf16 v[216:219], v[200:203], v[220:223], v[216:219]
    s_waitcnt lgkmcnt(4)
    v_mfma_f32_16x16x32_bf16 v[216:219], v[204:207], v[220:223], v[216:219]
    s_waitcnt lgkmcnt(2)
    v_mfma_f32_16x16x32_bf16 v[216:219], v[208:211], v[220:223], v[216:219]
    s_waitcnt lgkmcnt(0)
    v_mfma_f32_16x16x32_bf16 v[216:219], v[212:215], v[220:223], v[216:219]
    s_mov_b64 exec, s[66:67]
    s_nop 6
    ds_write_b128 v6, v[216:219]
    v_mov_b32 v4, 162816
    v_mov_b32 v7, 0
    ds_write_b32 v4, v7
    s_mov_b64 exec, -1
    s_waitcnt lgkmcnt(0)
    s_barrier
    v_lshrrev_b32 v4, 3, v2
    v_lshrrev_b32 v5, 5, v1
    v_lshl_add_u32 v4, v5, 1, v4
    v_and_b32 v5, 1, v3
    v_lshl_add_u32 v4, v4, 1, v5
    v_mul_u32_u24 v4, 3584, v4
    v_and_b32 v6, 7, v1
    v_lshl_add_u32 v15, v6, 4, v4
    s_mul_i32 s59, s4, 200704
    s_lshl_b32 s96, s52, 7
    s_add_u32 s59, s59, s96
    s_and_b32 s96, s53, 0xfffffff0
    s_or_b32 s97, s96, s101
    s_mov_b32 s78, 0
    s_mov_b64 exec, 0xffffffff
    s_waitcnt vmcnt(0)
L_hel_12:
    v_and_b32 v4, 0xfffffff0, v14
    v_cmp_ne_u32 vcc, s96, v4
    v_cmp_ne_u32 s[88:89], s97, v14
    s_nop 0
    s_cbranch_vccnz L_helre_13
L_helback_14:
    s_mov_b64 exec, -1
    s_cmp_eq_u64 s[88:89], 0
    s_cselect_b32 s7, 1, 0
    s_and_b32 s61, s4, 3
    s_lshl_b32 s61, s61, 12
    s_mul_i32 s60, s46, 75904
    s_add_u32 s63, s61, 57344
    s_add_u32 s63, s63, s60
    v_add_u32 v10, s63, v16
    s_add_u32 s63, s61, 133248
    s_sub_u32 s63, s63, s60
    v_add_u32 v11, s63, v16
    v_lshl_add_u32 v12, v3, 8, v16
    v_lshlrev_b32 v9, 2, v1
    s_lshl_b32 s61, s52, 1
    s_add_u32 s61, s61, s46
    s_mul_i32 s60, s86, 14
    s_add_u32 s60, s60, s61
    s_lshl_b32 s87, s60, 11
    s_lshl_b32 s60, s65, 4
    s_add_u32 s60, s60, s61
    s_lshl_b32 s60, s60, 2
    s_add_u32 s60, s60, s54
    s_add_u32 s99, s60, 2048
    s_mul_i32 s60, s86, 14
    s_add_u32 s60, s60, s52
    s_lshl_b32 s60, s60, 8
    s_lshl_b32 s61, s46, 3
    s_add_u32 s60, s60, s61
    s_add_u32 s84, s60, 1835008
    s_lshl_b32 s61, s65, 6
    s_lshl_b32 s63, s46, 5
    s_add_u32 s61, s61, s63
    s_add_u32 s61, s61, s54
    s_add_u32 s61, s61, 1024
    s_mul_i32 s60, s86, 114688
    s_lshl_b32 s63, s46, 13
    s_add_u32 s60, s60, s63
    s_add_u32 s60, s60, 2097152
    s_add_u32 s62, s60, 57344
    s_add_u32 s63, s60, 4096
    s_add_u32 s64, s62, 4096
    s_waitcnt vmcnt(0)
    v_lshlrev_b32 v224, 16, v20
    v_and_b32 v225, 0xffff0000, v20
    v_lshlrev_b32 v226, 16, v21
    v_and_b32 v227, 0xffff0000, v21
    v_lshlrev_b32 v228, 16, v22
    v_and_b32 v229, 0xffff0000, v22
    v_lshlrev_b32 v230, 16, v23
    v_and_b32 v231, 0xffff0000, v23
    v_lshlrev_b32 v240, 16, v24
    v_and_b32 v241, 0xffff0000, v24
    v_lshlrev_b32 v242, 16, v25
    v_and_b32 v243, 0xffff0000, v25
    v_lshlrev_b32 v244, 16, v26
    v_and_b32 v245, 0xffff0000, v26
    v_lshlrev_b32 v246, 16, v27
    v_and_b32 v247, 0xffff0000, v27
    s_mov_b32 exec_lo, 0xff
    s_mov_b32 exec_hi, 0x0
    s_mov_b32 s78, 0
L_poll_15:
    buffer_load_dword v4, v9, s[36:39], s61 offen sc1
    s_add_u32 s78, s78, 1
    s_cmp_ge_u32 s78, 200000
    s_cbranch_scc1 L_pollend_16
    s_waitcnt vmcnt(0)
    v_cmp_ne_u32 vcc, s53, v4
    s_nop 1
    s_cbranch_vccz L_pollend_16
    s_sleep 2
    s_branch L_poll_15
L_pollend_16:
    s_waitcnt vmcnt(0)
    s_mov_b64 exec, -1
    buffer_load_dwordx4 v[160:163], v16, s[36:39], s60 offen offset:0 sc1
    buffer_load_dwordx4 v[164:167], v16, s[36:39], s62 offen offset:0 sc1
    buffer_load_dwordx4 v[168:171], v16, s[36:39], s60 offen offset:1024 sc1
    buffer_load_dwordx4 v[172:175], v16, s[36:39], s62 offen offset:1024 sc1
    buffer_load_dwordx4 v[176:179], v16, s[36:39], s60 offen offset:2048 sc1
    s_waitcnt vmcnt(4)
    v_mfma_f32_16x16x32_bf16 v[232:235], v[40:43], v[160:163], 0
    v_mfma_f32_16x16x32_bf16 v[236:239], v[44:47], v[160:163], 0
    v_mfma_f32_16x16x32_bf16 v[224:227], v[32:35], v[160:163], v[224:227]
    v_mfma_f32_16x16x32_bf16 v[228:231], v[36:39], v[160:163], v[228:231]
    buffer_load_dwordx4 v[180:183], v16, s[36:39], s62 offen offset:2048 sc1
    s_waitcnt vmcnt(4)
    v_mfma_f32_16x16x32_bf16 v[248:251], v[40:43], v[164:167], 0
    v_mfma_f32_16x16x32_bf16 v[252:255], v[44:47], v[164:167], 0
    v_mfma_f32_16x16x32_bf16 v[240:243], v[32:35], v[164:167], v[240:243]
    v_mfma_f32_16x16x32_bf16 v[244:247], v[36:39], v[164:167], v[244:247]
    buffer_load_dwordx4 v[184:187], v16, s[36:39], s60 offen offset:3072 sc1
    s_waitcnt vmcnt(4)
    v_mfma_f32_16x16x32_bf16 v[232:235], v[56:59], v[168:171], v[232:235]
    v_mfma_f32_16x16x32_bf16 v[236:239], v[60:63], v[168:171], v[236:239]
    v_mfma_f32_16x16x32_bf16 v[224:227], v[48:51], v[168:171], v[224:227]
    v_mfma_f32_16x16x32_bf16 v[228:231], v[52:55], v[168:171], v[228:231]
    buffer_load_dwordx4 v[188:191], v16, s[36:39], s62 offen offset:3072 sc1
    s_waitcnt vmcnt(4)
    v_mfma_f32_16x16x32_bf16 v[248:251], v[56:59], v[172:175], v[248:251]
    v_mfma_f32_16x16x32_bf16 v[252:255], v[60:63], v[172:175], v[252:255]
    v_mfma_f32_16x16x32_bf16 v[240:243], v[48:51], v[172:175], v[240:243]
    v_mfma_f32_16x16x32_bf16 v[244:247], v[52:55], v[172:175], v[244:247]
    buffer_load_dwordx4 v[192:195], v16, s[36:39], s63 offen offset:0 sc1
    s_waitcnt vmcnt(4)
    v_mfma_f32_16x16x32_bf16 v[232:235], v[72:75], v[176:179], v[232:235]
    v_mfma_f32_16x16x32_bf16 v[236:239], v[76:79], v[176:179], v[236:239]
    v_mfma_f32_16x16x32_bf16 v[224:227], v[64:67], v[176:179], v[224:227]
    v_mfma_f32_16x16x32_bf16 v[228:231], v[68:71], v[176:179], v[228:231]
    buffer_load_dwordx4 v[196:199], v16, s[36:39], s64 offen offset:0 sc1
    s_waitcnt vmcnt(4)
    v_mfma_f32_16x16x32_bf16 v[248:251], v[72:75], v[180:183], v[248:251]
    v_mfma_f32_16x16x32_bf16 v[252:255], v[76:79], v[180:183], v[252:255]
    v_mfma_f32_16x16x32_bf16 v[240:243], v[64:67], v[180:183], v[240:243]
    v_mfma_f32_16x16x32_bf16 v[244:247], v[68:71], v[180:183], v[244:247]
    buffer_load_dwordx4 v[200:203], v16, s[36:39], s63 offen offset:1024 sc1
    s_waitcnt vmcnt(4)
    v_mfma_f32_16x16x32_bf16 v[232:235], v[88:91], v[184:187], v[232:235]
    v_mfma_f32_16x16x32_bf16 v[236:239], v[92:95], v[184:187], v[236:239]
    v_mfma_f32_16x16x32_bf16 v[224:227], v[80:83], v[184:187], v[224:227]
    v_mfma_f32_16x16x32_bf16 v[228:231], v[84:87], v[184:187], v[228:231]
    buffer_load_dwordx4 v[204:207], v16, s[36:39], s64 offen offset:1024 sc1
    s_waitcnt vmcnt(4)
    v_mfma_f32_16x16x32_bf16 v[248:251], v[88:91], v[188:191], v[248:251]
    v_mfma_f32_16x16x32_bf16 v[252:255], v[92:95], v[188:191], v[252:255]
    v_mfma_f32_16x16x32_bf16 v[240:243], v[80:83], v[188:191], v[240:243]
    v_mfma_f32_16x16x32_bf16 v[244:247], v[84:87], v[188:191], v[244:247]
    buffer_load_dwordx4 v[208:211], v16, s[36:39], s63 offen offset:2048 sc1
    s_waitcnt vmcnt(4)
    v_mfma_f32_16x16x32_bf16 v[232:235], v[104:107], v[192:195], v[232:235]
    v_mfma_f32_16x16x32_bf16 v[236:239], v[108:111], v[192:195], v[236:239]
    v_mfma_f32_16x16x32_bf16 v[224:227], v[96:99], v[192:195], v[224:227]
    v_mfma_f32_16x16x32_bf16 v[228:231], v[100:103], v[192:195], v[228:231]
    buffer_load_dwordx4 v[212:215], v16, s[36:39], s64 offen offset:2048 sc1
    s_waitcnt vmcnt(4)
    v_mfma_f32_16x16x32_bf16 v[248:251], v[104:107], v[196:199], v[248:251]
    v_mfma_f32_16x16x32_bf16 v[252:255], v[108:111], v[196:199], v[252:255]
    v_mfma_f32_16x16x32_bf16 v[240:243], v[96:99], v[196:199], v[240:243]
    v_mfma_f32_16x16x32_bf16 v[244:247], v[100:103], v[196:199], v[244:247]
    buffer_load_dwordx4 v[216:219], v16, s[36:39], s63 offen offset:3072 sc1
    s_waitcnt vmcnt(4)
    v_mfma_f32_16x16x32_bf16 v[232:235], v[120:123], v[200:203], v[232:235]
    v_mfma_f32_16x16x32_bf16 v[236:239], v[124:127], v[200:203], v[236:239]
    v_mfma_f32_16x16x32_bf16 v[224:227], v[112:115], v[200:203], v[224:227]
    v_mfma_f32_16x16x32_bf16 v[228:231], v[116:119], v[200:203], v[228:231]
    buffer_load_dwordx4 v[220:223], v16, s[36:39], s64 offen offset:3072 sc1
    s_waitcnt vmcnt(4)
    v_mfma_f32_16x16x32_bf16 v[248:251], v[120:123], v[204:207], v[248:251]
    v_mfma_f32_16x16x32_bf16 v[252:255], v[124:127], v[204:207], v[252:255]
    v_mfma_f32_16x16x32_bf16 v[240:243], v[112:115], v[204:207], v[240:243]
    v_mfma_f32_16x16x32_bf16 v[244:247], v[116:119], v[204:207], v[244:247]
    s_waitcnt vmcnt(3)
    v_mfma_f32_16x16x32_bf16 v[232:235], v[136:139], v[208:211], v[232:235]
    v_mfma_f32_16x16x32_bf16 v[236:239], v[140:143], v[208:211], v[236:239]
    v_mfma_f32_16x16x32_bf16 v[224:227], v[128:131], v[208:211], v[224:227]
    v_mfma_f32_16x16x32_bf16 v[228:231], v[132:135], v[208:211], v[228:231]
    s_waitcnt vmcnt(2)
    v_mfma_f32_16x16x32_bf16 v[248:251], v[136:139], v[212:215], v[248:251]
    v_mfma_f32_16x16x32_bf16 v[252:255], v[140:143], v[212:215], v[252:255]
    v_mfma_f32_16x16x32_bf16 v[240:243], v[128:131], v[212:215], v[240:243]
    v_mfma_f32_16x16x32_bf16 v[244:247], v[132:135], v[212:215], v[244:247]
    s_waitcnt vmcnt(1)
    v_mfma_f32_16x16x32_bf16 v[232:235], v[152:155], v[216:219], v[232:235]
    v_mfma_f32_16x16x32_bf16 v[236:239], v[156:159], v[216:219], v[236:239]
    v_mfma_f32_16x16x32_bf16 v[224:227], v[144:147], v[216:219], v[224:227]
    v_mfma_f32_16x16x32_bf16 v[228:231], v[148:151], v[216:219], v[228:231]
    s_waitcnt vmcnt(0)
    v_mfma_f32_16x16x32_bf16 v[248:251], v[152:155], v[220:223], v[248:251]
    v_mfma_f32_16x16x32_bf16 v[252:255], v[156:159], v[220:223], v[252:255]
    v_mfma_f32_16x16x32_bf16 v[240:243], v[144:147], v[220:223], v[240:243]
    v_mfma_f32_16x16x32_bf16 v[244:247], v[148:151], v[220:223], v[244:247]
    s_add_u32 s98, s59, 0
    buffer_load_dwordx4 v[32:35], v15, s[28:31], s98 offen offset:0
    buffer_load_dwordx4 v[36:39], v15, s[28:31], s98 offen offset:896
    buffer_load_dwordx4 v[40:43], v15, s[28:31], s98 offen offset:1792
    buffer_load_dwordx4 v[44:47], v15, s[28:31], s98 offen offset:2688
    ds_write_b128 v10, v[232:235] offset:0
    ds_write_b128 v10, v[236:239] offset:1024
    ds_write_b128 v10, v[248:251] offset:2048
    ds_write_b128 v10, v[252:255] offset:3072
    s_waitcnt lgkmcnt(0)
    s_barrier
    ds_read_b128 v[232:235], v11 offset:0
    ds_read_b128 v[236:239], v11 offset:1024
    ds_read_b128 v[248:251], v11 offset:2048
    ds_read_b128 v[252:255], v11 offset:3072
    s_waitcnt lgkmcnt(2)
    v_add_f32 v224, v224, v232
    v_add_f32 v225, v225, v233
    v_add_f32 v226, v226, v234
    v_add_f32 v227, v227, v235
    v_add_f32 v228, v228, v236
    v_add_f32 v229, v229, v237
    v_add_f32 v230, v230, v238
    v_add_f32 v231, v231, v239
    v_cvt_pk_bf16_f32 v160, v224, v225
    v_cvt_pk_bf16_f32 v161, v226, v227
    v_cvt_pk_bf16_f32 v162, v228, v229
    v_cvt_pk_bf16_f32 v163, v230, v231
    s_cmp_eq_u32 s7, 0
    s_cbranch_scc1 L_slow_17
    buffer_store_dwordx4 v[160:163], v12, s[36:39], s87 offen offset:0
L_back_18:
    s_waitcnt lgkmcnt(0)
    v_add_f32 v240, v240, v248
    v_add_f32 v241, v241, v249
    v_add_f32 v242, v242, v250
    v_add_f32 v243, v243, v251
    v_add_f32 v244, v244, v252
    v_add_f32 v245, v245, v253
    v_add_f32 v246, v246, v254
    v_add_f32 v247, v247, v255
    v_cvt_pk_bf16_f32 v164, v240, v241
    v_cvt_pk_bf16_f32 v165, v242, v243
    v_cvt_pk_bf16_f32 v166, v244, v245
    v_cvt_pk_bf16_f32 v167, v246, v247
    s_cmp_eq_u32 s7, 0
    s_cbranch_scc1 L_slow_19
    buffer_store_dwordx4 v[164:167], v12, s[36:39], s87 offen offset:256
L_back_20:
    v_lshlrev_b32 v224, 16, v160
    v_lshlrev_b32 v240, 16, v164
    v_and_b32 v225, 0xffff0000, v160
    v_and_b32 v241, 0xffff0000, v164
    v_lshlrev_b32 v226, 16, v161
    v_lshlrev_b32 v242, 16, v165
    v_and_b32 v227, 0xffff0000, v161
    v_and_b32 v243, 0xffff0000, v165
    v_lshlrev_b32 v228, 16, v162
    v_lshlrev_b32 v244, 16, v166
    v_and_b32 v229, 0xffff0000, v162
    v_and_b32 v245, 0xffff0000, v166
    v_lshlrev_b32 v230, 16, v163
    v_lshlrev_b32 v246, 16, v167
    v_and_b32 v231, 0xffff0000, v163
    v_and_b32 v247, 0xffff0000, v167
    v_mul_f32 v233, v224, v224
    v_mul_f32 v249, v240, v240
    v_mul_f32 v234, v225, v225
    v_mul_f32 v250, v241, v241
    v_add_f32 v232, v224, v225
    v_add_f32 v248, v240, v241
    v_add_f32 v235, v226, v227
    v_add_f32 v251, v242, v243
    v_fmac_f32 v233, v226, v226
    v_fmac_f32 v249, v242, v242
    v_fmac_f32 v234, v227, v227
    v_fmac_f32 v250, v243, v243
    v_fmac_f32 v233, v228, v228
    v_fmac_f32 v249, v244, v244
    v_fmac_f32 v234, v229, v229
    v_fmac_f32 v250, v245, v245
    v_fmac_f32 v233, v230, v230
    v_fmac_f32 v249, v246, v246
    v_fmac_f32 v234, v231, v231
    v_fmac_f32 v250, v247, v247
    v_add_f32 v236, v228, v229
    v_add_f32 v252, v244, v245
    v_add_f32 v237, v230, v231
    v_add_f32 v253, v246, v247
    v_add_f32 v232, v232, v235
    v_add_f32 v248, v248, v251
    v_add_f32 v236, v236, v237
    v_add_f32 v252, v252, v253
    v_add_f32 v233, v233, v234
    v_add_f32 v249, v249, v250
    v_add_f32 v232, v232, v236
    v_add_f32 v248, v248, v252
    v_mov_b32 v10, s53
    v_mov_b32 v11, 0
    s_waitcnt vmcnt(0)
    s_mov_b64 exec, 1
    s_cmp_eq_u32 s7, 0
    s_cbranch_scc1 L_slow_21
    buffer_store_dword v10, v11, s[36:39], s99 offen
L_back_22:
    s_mov_b64 exec, -1
    s_add_u32 s99, s99, 512
    v_mov_b32 v238, v232
    v_mov_b32 v239, v233
    v_mov_b32 v254, v248
    v_mov_b32 v255, v249
    v_permlane32_swap_b32 v232, v238
    v_permlane32_swap_b32 v233, v239
    v_permlane32_swap_b32 v248, v254
    v_permlane32_swap_b32 v249, v255
    v_add_f32 v232, v232, v238
    v_add_f32 v233, v233, v239
    v_add_f32 v248, v248, v254
    v_add_f32 v249, v249, v255
    v_mov_b32 v238, v232
    v_mov_b32 v239, v233
    v_mov_b32 v254, v248
    v_mov_b32 v255, v249
    v_permlane16_swap_b32 v232, v238
    v_permlane16_swap_b32 v233, v239
    v_permlane16_swap_b32 v248, v254
    v_permlane16_swap_b32 v249, v255
    v_add_f32 v232, v232, v238
    v_add_f32 v233, v233, v239
    v_add_f32 v248, v248, v254
    v_add_f32 v249, v249, v255
    s_mov_b64 exec, 0xffff
    s_cmp_eq_u32 s7, 0
    s_cbranch_scc1 L_slow_23
    buffer_store_dwordx2 v[232:233], v16, s[36:39], s84 offen offset:0
L_back_24:
    s_cmp_eq_u32 s7, 0
    s_cbranch_scc1 L_slow_25
    buffer_store_dwordx2 v[248:249], v16, s[36:39], s84 offen offset:1792
L_back_26:
    s_mov_b64 exec, -1
    v_bfe_u32 v4, v1, 2, 2
    v_lshrrev_b32 v8, 5, v1
    v_lshl_add_u32 v5, v8, 2, v4
    v_lshrrev_b32 v6, 1, v5
    v_and_b32 v9, 1, v3
    v_lshlrev_b32 v7, 1, v9
    v_xor_b32 v6, v6, v7
    v_lshlrev_b32 v5, 7, v5
    v_lshl_add_u32 v5, v6, 5, v5
    v_and_b32 v7, 3, v1
    v_lshl_add_u32 v5, v7, 3, v5
    v_mul_u32_u24 v6, 75904, v9
    v_add_u32 v6, 0, v6
    v_xor_b32 v10, 0, v5
    v_add_u32 v17, v6, v10
    v_xor_b32 v10, 32, v5
    v_add_u32 v18, v6, v10
    v_xor_b32 v10, 64, v5
    v_add_u32 v19, v6, v10
    v_xor_b32 v10, 96, v5
    v_add_u32 v20, v6, v10
    v_lshlrev_b32 v4, 4, v2
    v_lshl_add_u32 v4, v8, 8, v4
    v_mul_u32_u24 v6, 57344, v9
    v_add_u32 v22, v4, v6
    v_mul_u32_u24 v6, 1792, v9
    v_add_u32 v21, v4, v6
    v_lshlrev_b32 v23, 4, v8
    v_add_u32 v23, 159232, v23
    s_mov_b32 s65, s4
    s_lshl_b32 s64, s5, 3
    s_add_u32 s64, s64, s65
    s_mul_i32 s84, s64, 114688
    s_lshl_b32 s61, s49, 11
    s_add_u32 s84, s84, s61
    s_add_u32 s84, s84, 2097152
    s_lshl_b32 s61, s65, 5
    s_add_u32 s61, s61, s49
    s_lshl_b32 s61, s61, 2
    s_add_u32 s61, s61, s54
    s_add_u32 s85, s61, 3072
    s_lshl_b32 s61, s65, 6
    s_add_u32 s61, s61, s54
    s_add_u32 s62, s61, 2048
    s_mul_i32 s60, s64, 28672
    s_mul_i32 s63, s64, 3584
    s_add_u32 s63, s63, 1835008
    v_mov_b32 v12, s53
    v_mov_b32 v13, 0
    s_waitcnt vmcnt(0)
    s_mov_b64 exec, 1
    s_cmp_eq_u32 s7, 0
    s_cbranch_scc1 L_slow_27
    buffer_store_dword v12, v13, s[36:39], s99 offen
L_back_28:
    s_mov_b64 exec, -1
L_p3:
    s_nop 1
    ds_read_b64_tr_b16 v[224:225], v17 offset:0
    ds_read_b64_tr_b16 v[226:227], v17 offset:2048
    ds_read_b64_tr_b16 v[228:229], v18 offset:0
    ds_read_b64_tr_b16 v[230:231], v18 offset:2048
    ds_read_b64_tr_b16 v[232:233], v19 offset:0
    ds_read_b64_tr_b16 v[234:235], v19 offset:2048
    ds_read_b64_tr_b16 v[236:237], v20 offset:0
    ds_read_b64_tr_b16 v[238:239], v20 offset:2048
    ds_read_b64_tr_b16 v[24:25], v17 offset:1024
    ds_read_b64_tr_b16 v[26:27], v17 offset:3072
    v_lshlrev_b32 v5, 2, v1
    s_mov_b32 s76, 0x05040100
    s_mov_b32 s77, 0x07060302
    s_mov_b32 s88, 0xff00ff00
    s_mov_b32 s89, 0xff00ff00
    v_mov_b32 v252, 0
    v_mov_b32 v253, 0
    v_mov_b32 v254, 0
    v_mov_b32 v255, 0
    s_mov_b32 exec_lo, 0x3fff
    s_mov_b32 exec_hi, 0x0
    s_mov_b32 s78, 0
L_poll_29:
    buffer_load_dword v4, v5, s[36:39], s62 offen sc1
    s_add_u32 s78, s78, 1
    s_cmp_ge_u32 s78, 200000
    s_cbranch_scc1 L_pollend_30
    s_waitcnt vmcnt(0)
    v_cmp_ne_u32 vcc, s53, v4
    s_nop 1
    s_cbranch_vccz L_pollend_30
    s_sleep 2
    s_branch L_poll_29
L_pollend_30:
    s_waitcnt vmcnt(0)
    s_mov_b64 exec, -1
    buffer_load_dwordx4 v[128:131], v16, s[36:39], s60 offen offset:0 sc1
    buffer_load_dwordx4 v[132:135], v16, s[36:39], s60 offen offset:1024 sc1
    buffer_load_dwordx4 v[136:139], v16, s[36:39], s60 offen offset:2048 sc1
    buffer_load_dwordx4 v[140:143], v16, s[36:39], s60 offen offset:3072 sc1
    s_add_u32 s60, s60, 4096
    buffer_load_dwordx4 v[144:147], v16, s[36:39], s60 offen offset:0 sc1
    buffer_load_dwordx4 v[148:151], v16, s[36:39], s60 offen offset:1024 sc1
    buffer_load_dwordx4 v[152:155], v16, s[36:39], s60 offen offset:2048 sc1
    buffer_load_dwordx4 v[156:159], v16, s[36:39], s60 offen offset:3072 sc1
    s_add_u32 s60, s60, 4096
    ds_read_b64_tr_b16 v[4:5], v18 offset:1024
    ds_read_b64_tr_b16 v[6:7], v18 offset:3072
    s_waitcnt vmcnt(7)
    s_waitcnt lgkmcnt(10)
    v_mfma_f32_32x32x16_bf16 v[160:175], v[224:227], v[128:131], 0
    ds_read_b64_tr_b16 v[8:9], v19 offset:1024
    ds_read_b64_tr_b16 v[10:11], v19 offset:3072
    s_waitcnt lgkmcnt(10)
    v_mfma_f32_32x32x16_bf16 v[176:191], v[228:231], v[128:131], 0
    ds_read_b64_tr_b16 v[224:225], v20 offset:1024
    ds_read_b64_tr_b16 v[226:227], v20 offset:3072
    s_waitcnt lgkmcnt(10)
    v_mfma_f32_32x32x16_bf16 v[192:207], v[232:235], v[128:131], 0
    ds_read_b64_tr_b16 v[228:229], v17 offset:4096
    ds_read_b64_tr_b16 v[230:231], v17 offset:6144
    s_waitcnt lgkmcnt(10)
    v_mfma_f32_32x32x16_bf16 v[208:223], v[236:239], v[128:131], 0
    ds_read_b64_tr_b16 v[232:233], v18 offset:4096
    ds_read_b64_tr_b16 v[234:235], v18 offset:6144
    buffer_load_dwordx4 v[128:131], v16, s[36:39], s60 offen offset:0 sc1
    s_waitcnt vmcnt(7)
    s_waitcnt lgkmcnt(10)
    v_mfma_f32_32x32x16_bf16 v[160:175], v[24:27], v[132:135], v[160:175]
    ds_read_b64_tr_b16 v[236:237], v19 offset:4096
    ds_read_b64_tr_b16 v[238:239], v19 offset:6144
    s_waitcnt lgkmcnt(10)
    v_mfma_f32_32x32x16_bf16 v[176:191], v[4:7], v[132:135], v[176:191]
    ds_read_b64_tr_b16 v[24:25], v20 offset:4096
    ds_read_b64_tr_b16 v[26:27], v20 offset:6144
    s_add_u32 s98, s59, 28672
    buffer_load_dwordx4 v[48:51], v15, s[28:31], s98 offen offset:0
    s_waitcnt lgkmcnt(10)
    v_mfma_f32_32x32x16_bf16 v[192:207], v[8:11], v[132:135], v[192:207]
    ds_read_b64_tr_b16 v[4:5], v17 offset:5120
    ds_read_b64_tr_b16 v[6:7], v17 offset:7168
    s_waitcnt lgkmcnt(10)
    v_mfma_f32_32x32x16_bf16 v[208:223], v[224:227], v[132:135], v[208:223]
    ds_read_b64_tr_b16 v[8:9], v18 offset:5120
    ds_read_b64_tr_b16 v[10:11], v18 offset:7168
    buffer_load_dwordx4 v[132:135], v16, s[36:39], s60 offen offset:1024 sc1
    s_waitcnt vmcnt(8)
    s_waitcnt lgkmcnt(10)
    v_mfma_f32_32x32x16_bf16 v[160:175], v[228:231], v[136:139], v[160:175]
    ds_read_b64_tr_b16 v[224:225], v19 offset:5120
    ds_read_b64_tr_b16 v[226:227], v19 offset:7168
    s_waitcnt lgkmcnt(10)
    v_mfma_f32_32x32x16_bf16 v[176:191], v[232:235], v[136:139], v[176:191]
    ds_read_b64_tr_b16 v[228:229], v20 offset:5120
    ds_read_b64_tr_b16 v[230:231], v20 offset:7168
    buffer_load_dwordx4 v[52:55], v15, s[28:31], s98 offen offset:896
    s_waitcnt lgkmcnt(10)
    v_mfma_f32_32x32x16_bf16 v[192:207], v[236:239], v[136:139], v[192:207]
    ds_read_b64_tr_b16 v[232:233], v17 offset:8192
    ds_read_b64_tr_b16 v[234:235], v17 offset:10240
    s_waitcnt lgkmcnt(10)
    v_mfma_f32_32x32x16_bf16 v[208:223], v[24:27], v[136:139], v[208:223]
    ds_read_b64_tr_b16 v[236:237], v18 offset:8192
    ds_read_b64_tr_b16 v[238:239], v18 offset:10240
    buffer_load_dwordx4 v[136:139], v16, s[36:39], s60 offen offset:2048 sc1
    s_waitcnt vmcnt(9)
    s_waitcnt lgkmcnt(10)
    v_mfma_f32_32x32x16_bf16 v[160:175], v[4:7], v[140:143], v[160:175]
    ds_read_b64_tr_b16 v[24:25], v19 offset:8192
    ds_read_b64_tr_b16 v[26:27], v19 offset:10240
    s_waitcnt lgkmcnt(10)
    v_mfma_f32_32x32x16_bf16 v[176:191], v[8:11], v[140:143], v[176:191]
    ds_read_b64_tr_b16 v[4:5], v20 offset:8192
    ds_read_b64_tr_b16 v[6:7], v20 offset:10240
    buffer_load_dwordx4 v[56:59], v15, s[28:31], s98 offen offset:1792
    s_waitcnt lgkmcnt(10)
    v_mfma_f32_32x32x16_bf16 v[192:207], v[224:227], v[140:143], v[192:207]
    ds_read_b64_tr_b16 v[8:9], v17 offset:9216
    ds_read_b64_tr_b16 v[10:11], v17 offset:11264
    s_waitcnt lgkmcnt(10)
    v_mfma_f32_32x32x16_bf16 v[208:223], v[228:231], v[140:143], v[208:223]
    ds_read_b64_tr_b16 v[224:225], v18 offset:9216
    ds_read_b64_tr_b16 v[226:227], v18 offset:11264
    buffer_load_dwordx4 v[140:143], v16, s[36:39], s60 offen offset:3072 sc1
    s_add_u32 s60, s60, 4096
    s_waitcnt vmcnt(10)
    s_waitcnt lgkmcnt(10)
    v_mfma_f32_32x32x16_bf16 v[160:175], v[232:235], v[144:147], v[160:175]
    ds_read_b64_tr_b16 v[228:229], v19 offset:9216
    ds_read_b64_tr_b16 v[230:231], v19 offset:11264
    s_waitcnt lgkmcnt(10)
    v_mfma_f32_32x32x16_bf16 v[176:191], v[236:239], v[144:147], v[176:191]
    ds_read_b64_tr_b16 v[232:233], v20 offset:9216
    ds_read_b64_tr_b16 v[234:235], v20 offset:11264
    buffer_load_dwordx4 v[60:63], v15, s[28:31], s98 offen offset:2688
    s_waitcnt lgkmcnt(10)
    v_mfma_f32_32x32x16_bf16 v[192:207], v[24:27], v[144:147], v[192:207]
    ds_read_b64_tr_b16 v[236:237], v17 offset:12288
    ds_read_b64_tr_b16 v[238:239], v17 offset:14336
    v_perm_b32 v240, v36, v32, s76
    v_perm_b32 v248, v38, v34, s76
    v_perm_b32 v241, v36, v32, s77
    v_perm_b32 v249, v38, v34, s77
    s_waitcnt lgkmcnt(10)
    v_mfma_f32_32x32x16_bf16 v[208:223], v[4:7], v[144:147], v[208:223]
    ds_read_b64_tr_b16 v[24:25], v18 offset:12288
    ds_read_b64_tr_b16 v[26:27], v18 offset:14336
    v_perm_b32 v242, v37, v33, s76
    v_perm_b32 v250, v39, v35, s76
    v_perm_b32 v243, v37, v33, s77
    v_perm_b32 v251, v39, v35, s77
    buffer_load_dwordx4 v[144:147], v16, s[36:39], s60 offen offset:0 sc1
    s_waitcnt vmcnt(11)
    s_waitcnt lgkmcnt(10)
    v_mfma_f32_32x32x16_bf16 v[160:175], v[8:11], v[148:151], v[160:175]
    ds_read_b64_tr_b16 v[4:5], v19 offset:12288
    ds_read_b64_tr_b16 v[6:7], v19 offset:14336
    v_perm_b32 v244, v44, v40, s76
    v_perm_b32 v252, v46, v42, s76
    v_perm_b32 v245, v44, v40, s77
    v_perm_b32 v253, v46, v42, s77
    s_waitcnt lgkmcnt(10)
    v_mfma_f32_32x32x16_bf16 v[176:191], v[224:227], v[148:151], v[176:191]
    ds_read_b64_tr_b16 v[8:9], v20 offset:12288
    ds_read_b64_tr_b16 v[10:11], v20 offset:14336
    v_perm_b32 v246, v45, v41, s76
    v_perm_b32 v254, v47, v43, s76
    v_perm_b32 v247, v45, v41, s77
    v_perm_b32 v255, v47, v43, s77
    s_add_u32 s98, s59, 57344
    buffer_load_dwordx4 v[64:67], v15, s[28:31], s98 offen offset:0
    s_waitcnt lgkmcnt(10)
    v_mfma_f32_32x32x16_bf16 v[192:207], v[228:231], v[148:151], v[192:207]
    ds_read_b64_tr_b16 v[224:225], v17 offset:13312
    ds_read_b64_tr_b16 v[226:227], v17 offset:15360
    s_mov_b64 vcc, s[88:89]
    v_cndmask_b32_dpp v34, v240, v248, vcc row_ror:8 row_mask:0xf bank_mask:0xf
    v_cndmask_b32_dpp v38, v241, v249, vcc row_ror:8 row_mask:0xf bank_mask:0xf
    s_waitcnt lgkmcnt(10)
    v_mfma_f32_32x32x16_bf16 v[208:223], v[232:235], v[148:151], v[208:223]
    ds_read_b64_tr_b16 v[228:229], v18 offset:13312
    ds_read_b64_tr_b16 v[230:231], v18 offset:15360
    v_cndmask_b32_dpp v42, v242, v250, vcc row_ror:8 row_mask:0xf bank_mask:0xf
    v_cndmask_b32_dpp v46, v243, v251, vcc row_ror:8 row_mask:0xf bank_mask:0xf
    v_cndmask_b32_dpp v35, v244, v252, vcc row_ror:8 row_mask:0xf bank_mask:0xf
    buffer_load_dwordx4 v[148:151], v16, s[36:39], s60 offen offset:1024 sc1
    s_waitcnt vmcnt(12)
    s_waitcnt lgkmcnt(10)
    v_mfma_f32_32x32x16_bf16 v[160:175], v[236:239], v[152:155], v[160:175]
    ds_read_b64_tr_b16 v[232:233], v19 offset:13312
    ds_read_b64_tr_b16 v[234:235], v19 offset:15360
    v_cndmask_b32_dpp v39, v245, v253, vcc row_ror:8 row_mask:0xf bank_mask:0xf
    v_cndmask_b32_dpp v43, v246, v254, vcc row_ror:8 row_mask:0xf bank_mask:0xf
    v_cndmask_b32_dpp v47, v247, v255, vcc row_ror:8 row_mask:0xf bank_mask:0xf
    s_waitcnt lgkmcnt(10)
    v_mfma_f32_32x32x16_bf16 v[176:191], v[24:27], v[152:155], v[176:191]
    ds_read_b64_tr_b16 v[236:237], v20 offset:13312
    ds_read_b64_tr_b16 v[238:239], v20 offset:15360
    s_not_b64 vcc, s[88:89]
    v_cndmask_b32_dpp v32, v248, v240, vcc row_ror:8 row_mask:0xf bank_mask:0xf
    v_cndmask_b32_dpp v36, v249, v241, vcc row_ror:8 row_mask:0xf bank_mask:0xf
    buffer_load_dwordx4 v[68:71], v15, s[28:31], s98 offen offset:896
    s_waitcnt lgkmcnt(10)
    v_mfma_f32_32x32x16_bf16 v[192:207], v[4:7], v[152:155], v[192:207]
    ds_read_b64_tr_b16 v[24:25], v17 offset:16384
    ds_read_b64_tr_b16 v[26:27], v17 offset:18432
    v_cndmask_b32_dpp v40, v250, v242, vcc row_ror:8 row_mask:0xf bank_mask:0xf
    v_cndmask_b32_dpp v44, v251, v243, vcc row_ror:8 row_mask:0xf bank_mask:0xf
    v_cndmask_b32_dpp v33, v252, v244, vcc row_ror:8 row_mask:0xf bank_mask:0xf
    s_waitcnt lgkmcnt(10)
    v_mfma_f32_32x32x16_bf16 v[208:223], v[8:11], v[152:155], v[208:223]
    ds_read_b64_tr_b16 v[4:5], v18 offset:16384
    ds_read_b64_tr_b16 v[6:7], v18 offset:18432
    v_cndmask_b32_dpp v37, v253, v245, vcc row_ror:8 row_mask:0xf bank_mask:0xf
    v_cndmask_b32_dpp v41, v254, v246, vcc row_ror:8 row_mask:0xf bank_mask:0xf
    v_cndmask_b32_dpp v45, v255, v247, vcc row_ror:8 row_mask:0xf bank_mask:0xf
    buffer_load_dwordx4 v[152:155], v16, s[36:39], s60 offen offset:2048 sc1
    s_waitcnt vmcnt(13)
    s_waitcnt lgkmcnt(10)
    v_mfma_f32_32x32x16_bf16 v[160:175], v[224:227], v[156:159], v[160:175]
    ds_read_b64_tr_b16 v[8:9], v19 offset:16384
    ds_read_b64_tr_b16 v[10:11], v19 offset:18432
    s_waitcnt vmcnt(5)
    v_perm_b32 v240, v52, v48, s76
    v_perm_b32 v248, v54, v50, s76
    v_perm_b32 v241, v52, v48, s77
    s_waitcnt lgkmcnt(10)
    v_mfma_f32_32x32x16_bf16 v[176:191], v[228:231], v[156:159], v[176:191]
    ds_read_b64_tr_b16 v[224:225], v20 offset:16384
    ds_read_b64_tr_b16 v[226:227], v20 offset:18432
    v_perm_b32 v249, v54, v50, s77
    v_perm_b32 v242, v53, v49, s76
    v_perm_b32 v250, v55, v51, s76
    v_perm_b32 v243, v53, v49, s77
    buffer_load_dwordx4 v[72:75], v15, s[28:31], s98 offen offset:1792
    s_waitcnt lgkmcnt(10)
    v_mfma_f32_32x32x16_bf16 v[192:207], v[232:235], v[156:159], v[192:207]
    ds_read_b64_tr_b16 v[228:229], v17 offset:17408
    ds_read_b64_tr_b16 v[230:231], v17 offset:19456
    v_perm_b32 v251, v55, v51, s77
    v_perm_b32 v244, v60, v56, s76
    v_perm_b32 v252, v62, v58, s76
    v_perm_b32 v245, v60, v56, s77
    s_waitcnt lgkmcnt(10)
    v_mfma_f32_32x32x16_bf16 v[208:223], v[236:239], v[156:159], v[208:223]
    ds_read_b64_tr_b16 v[232:233], v18 offset:17408
    ds_read_b64_tr_b16 v[234:235], v18 offset:19456
    v_perm_b32 v253, v62, v58, s77
    v_perm_b32 v246, v61, v57, s76
    v_perm_b32 v254, v63, v59, s76
    v_perm_b32 v247, v61, v57, s77
    buffer_load_dwordx4 v[156:159], v16, s[36:39], s60 offen offset:3072 sc1
    s_add_u32 s60, s60, 4096
    s_waitcnt vmcnt(14)
    s_waitcnt lgkmcnt(10)
    v_mfma_f32_32x32x16_bf16 v[160:175], v[24:27], v[128:131], v[160:175]
    ds_read_b64_tr_b16 v[236:237], v19 offset:17408
    ds_read_b64_tr_b16 v[238:239], v19 offset:19456
    v_perm_b32 v255, v63, v59, s77
    s_mov_b64 vcc, s[88:89]
    v_cndmask_b32_dpp v50, v240, v248, vcc row_ror:8 row_mask:0xf bank_mask:0xf
    v_cndmask_b32_dpp v54, v241, v249, vcc row_ror:8 row_mask:0xf bank_mask:0xf
    s_waitcnt lgkmcnt(10)
    v_mfma_f32_32x32x16_bf16 v[176:191], v[4:7], v[128:131], v[176:191]
    ds_read_b64_tr_b16 v[24:25], v20 offset:17408
    ds_read_b64_tr_b16 v[26:27], v20 offset:19456
    v_cndmask_b32_dpp v58, v242, v250, vcc row_ror:8 row_mask:0xf bank_mask:0xf
    v_cndmask_b32_dpp v62, v243, v251, vcc row_ror:8 row_mask:0xf bank_mask:0xf
    v_cndmask_b32_dpp v51, v244, v252, vcc row_ror:8 row_mask:0xf bank_mask:0xf
    buffer_load_dwordx4 v[76:79], v15, s[28:31], s98 offen offset:2688
    s_waitcnt lgkmcnt(10)
    v_mfma_f32_32x32x16_bf16 v[192:207], v[8:11], v[128:131], v[192:207]
    ds_read_b64_tr_b16 v[4:5], v17 offset:20480
    ds_read_b64_tr_b16 v[6:7], v17 offset:22528
    v_cndmask_b32_dpp v55, v245, v253, vcc row_ror:8 row_mask:0xf bank_mask:0xf
    v_cndmask_b32_dpp v59, v246, v254, vcc row_ror:8 row_mask:0xf bank_mask:0xf
    v_cndmask_b32_dpp v63, v247, v255, vcc row_ror:8 row_mask:0xf bank_mask:0xf
    s_waitcnt lgkmcnt(10)
    v_mfma_f32_32x32x16_bf16 v[208:223], v[224:227], v[128:131], v[208:223]
    ds_read_b64_tr_b16 v[8:9], v18 offset:20480
    ds_read_b64_tr_b16 v[10:11], v18 offset:22528
    s_not_b64 vcc, s[88:89]
    v_cndmask_b32_dpp v48, v248, v240, vcc row_ror:8 row_mask:0xf bank_mask:0xf
    v_cndmask_b32_dpp v52, v249, v241, vcc row_ror:8 row_mask:0xf bank_mask:0xf
    buffer_load_dwordx4 v[128:131], v16, s[36:39], s60 offen offset:0 sc1
    s_waitcnt vmcnt(14)
    s_waitcnt lgkmcnt(10)
    v_mfma_f32_32x32x16_bf16 v[160:175], v[228:231], v[132:135], v[160:175]
    ds_read_b64_tr_b16 v[224:225], v19 offset:20480
    ds_read_b64_tr_b16 v[226:227], v19 offset:22528
    v_cndmask_b32_dpp v56, v250, v242, vcc row_ror:8 row_mask:0xf bank_mask:0xf
    v_cndmask_b32_dpp v60, v251, v243, vcc row_ror:8 row_mask:0xf bank_mask:0xf
    v_cndmask_b32_dpp v49, v252, v244, vcc row_ror:8 row_mask:0xf bank_mask:0xf
    s_waitcnt lgkmcnt(10)
    v_mfma_f32_32x32x16_bf16 v[176:191], v[232:235], v[132:135], v[176:191]
    ds_read_b64_tr_b16 v[228:229], v20 offset:20480
    ds_read_b64_tr_b16 v[230:231], v20 offset:22528
    v_cndmask_b32_dpp v53, v253, v245, vcc row_ror:8 row_mask:0xf bank_mask:0xf
    v_cndmask_b32_dpp v57, v254, v246, vcc row_ror:8 row_mask:0xf bank_mask:0xf
    v_cndmask_b32_dpp v61, v255, v247, vcc row_ror:8 row_mask:0xf bank_mask:0xf
    s_add_u32 s98, s59, 86016
    buffer_load_dwordx4 v[80:83], v15, s[28:31], s98 offen offset:0
    s_waitcnt lgkmcnt(10)
    v_mfma_f32_32x32x16_bf16 v[192:207], v[236:239], v[132:135], v[192:207]
    ds_read_b64_tr_b16 v[232:233], v17 offset:21504
    ds_read_b64_tr_b16 v[234:235], v17 offset:23552
    s_waitcnt lgkmcnt(10)
    v_mfma_f32_32x32x16_bf16 v[208:223], v[24:27], v[132:135], v[208:223]
    ds_read_b64_tr_b16 v[236:237], v18 offset:21504
    ds_read_b64_tr_b16 v[238:239], v18 offset:23552
    buffer_load_dwordx4 v[132:135], v16, s[36:39], s60 offen offset:1024 sc1
    s_waitcnt vmcnt(14)
    s_waitcnt lgkmcnt(10)
    v_mfma_f32_32x32x16_bf16 v[160:175], v[4:7], v[136:139], v[160:175]
    ds_read_b64_tr_b16 v[24:25], v19 offset:21504
    ds_read_b64_tr_b16 v[26:27], v19 offset:23552
    s_waitcnt lgkmcnt(10)
    v_mfma_f32_32x32x16_bf16 v[176:191], v[8:11], v[136:139], v[176:191]
    ds_read_b64_tr_b16 v[4:5], v20 offset:21504
    ds_read_b64_tr_b16 v[6:7], v20 offset:23552
    buffer_load_dwordx4 v[84:87], v15, s[28:31], s98 offen offset:896
    s_waitcnt lgkmcnt(10)
    v_mfma_f32_32x32x16_bf16 v[192:207], v[224:227], v[136:139], v[192:207]
    ds_read_b64_tr_b16 v[8:9], v17 offset:24576
    ds_read_b64_tr_b16 v[10:11], v17 offset:26624
    s_waitcnt lgkmcnt(10)
    v_mfma_f32_32x32x16_bf16 v[208:223], v[228:231], v[136:139], v[208:223]
    ds_read_b64_tr_b16 v[224:225], v18 offset:24576
    ds_read_b64_tr_b16 v[226:227], v18 offset:26624
    buffer_load_dwordx4 v[136:139], v16, s[36:39], s60 offen offset:2048 sc1
    s_waitcnt vmcnt(14)
    s_waitcnt lgkmcnt(10)
    v_mfma_f32_32x32x16_bf16 v[160:175], v[232:235], v[140:143], v[160:175]
    ds_read_b64_tr_b16 v[228:229], v19 offset:24576
    ds_read_b64_tr_b16 v[230:231], v19 offset:26624
    s_waitcnt vmcnt(5)
    v_perm_b32 v240, v68, v64, s76
    v_perm_b32 v248, v70, v66, s76
    v_perm_b32 v241, v68, v64, s77
    s_waitcnt lgkmcnt(10)
    v_mfma_f32_32x32x16_bf16 v[176:191], v[236:239], v[140:143], v[176:191]
    ds_read_b64_tr_b16 v[232:233], v20 offset:24576
    ds_read_b64_tr_b16 v[234:235], v20 offset:26624
    v_perm_b32 v249, v70, v66, s77
    v_perm_b32 v242, v69, v65, s76
    v_perm_b32 v250, v71, v67, s76
    v_perm_b32 v243, v69, v65, s77
    buffer_load_dwordx4 v[88:91], v15, s[28:31], s98 offen offset:1792
    s_waitcnt lgkmcnt(10)
    v_mfma_f32_32x32x16_bf16 v[192:207], v[24:27], v[140:143], v[192:207]
    ds_read_b64_tr_b16 v[236:237], v17 offset:25600
    ds_read_b64_tr_b16 v[238:239], v17 offset:27648
    v_perm_b32 v251, v71, v67, s77
    v_perm_b32 v244, v76, v72, s76
    v_perm_b32 v252, v78, v74, s76
    v_perm_b32 v245, v76, v72, s77
    s_waitcnt lgkmcnt(10)
    v_mfma_f32_32x32x16_bf16 v[208:223], v[4:7], v[140:143], v[208:223]
    ds_read_b64_tr_b16 v[24:25], v18 offset:25600
    ds_read_b64_tr_b16 v[26:27], v18 offset:27648
    v_perm_b32 v253, v78, v74, s77
    v_perm_b32 v246, v77, v73, s76
    v_perm_b32 v254, v79, v75, s76
    v_perm_b32 v247, v77, v73, s77
    buffer_load_dwordx4 v[140:143], v16, s[36:39], s60 offen offset:3072 sc1
    s_add_u32 s60, s60, 4096
    s_waitcnt vmcnt(14)
    s_waitcnt lgkmcnt(10)
    v_mfma_f32_32x32x16_bf16 v[160:175], v[8:11], v[144:147], v[160:175]
    ds_read_b64_tr_b16 v[4:5], v19 offset:25600
    ds_read_b64_tr_b16 v[6:7], v19 offset:27648
    v_perm_b32 v255, v79, v75, s77
    s_mov_b64 vcc, s[88:89]
    v_cndmask_b32_dpp v66, v240, v248, vcc row_ror:8 row_mask:0xf bank_mask:0xf
    v_cndmask_b32_dpp v70, v241, v249, vcc row_ror:8 row_mask:0xf bank_mask:0xf
    s_waitcnt lgkmcnt(10)
    v_mfma_f32_32x32x16_bf16 v[176:191], v[224:227], v[144:147], v[176:191]
    ds_read_b64_tr_b16 v[8:9], v20 offset:25600
    ds_read_b64_tr_b16 v[10:11], v20 offset:27648
    v_cndmask_b32_dpp v74, v242, v250, vcc row_ror:8 row_mask:0xf bank_mask:0xf
    v_cndmask_b32_dpp v78, v243, v251, vcc row_ror:8 row_mask:0xf bank_mask:0xf
    v_cndmask_b32_dpp v67, v244, v252, vcc row_ror:8 row_mask:0xf bank_mask:0xf
    buffer_load_dwordx4 v[92:95], v15, s[28:31], s98 offen offset:2688
    s_waitcnt lgkmcnt(10)
    v_mfma_f32_32x32x16_bf16 v[192:207], v[228:231], v[144:147], v[192:207]
    ds_read_b64_tr_b16 v[224:225], v17 offset:28672
    ds_read_b64_tr_b16 v[226:227], v17 offset:30720
    v_cndmask_b32_dpp v71, v245, v253, vcc row_ror:8 row_mask:0xf bank_mask:0xf
    v_cndmask_b32_dpp v75, v246, v254, vcc row_ror:8 row_mask:0xf bank_mask:0xf
    v_cndmask_b32_dpp v79, v247, v255, vcc row_ror:8 row_mask:0xf bank_mask:0xf
    s_waitcnt lgkmcnt(10)
    v_mfma_f32_32x32x16_bf16 v[208:223], v[232:235], v[144:147], v[208:223]
    ds_read_b64_tr_b16 v[228:229], v18 offset:28672
    ds_read_b64_tr_b16 v[230:231], v18 offset:30720
    s_not_b64 vcc, s[88:89]
    v_cndmask_b32_dpp v64, v248, v240, vcc row_ror:8 row_mask:0xf bank_mask:0xf
    v_cndmask_b32_dpp v68, v249, v241, vcc row_ror:8 row_mask:0xf bank_mask:0xf
    buffer_load_dwordx4 v[144:147], v16, s[36:39], s60 offen offset:0 sc1
    s_waitcnt vmcnt(14)
    s_waitcnt lgkmcnt(10)
    v_mfma_f32_32x32x16_bf16 v[160:175], v[236:239], v[148:151], v[160:175]
    ds_read_b64_tr_b16 v[232:233], v19 offset:28672
    ds_read_b64_tr_b16 v[234:235], v19 offset:30720
    v_cndmask_b32_dpp v72, v250, v242, vcc row_ror:8 row_mask:0xf bank_mask:0xf
    v_cndmask_b32_dpp v76, v251, v243, vcc row_ror:8 row_mask:0xf bank_mask:0xf
    v_cndmask_b32_dpp v65, v252, v244, vcc row_ror:8 row_mask:0xf bank_mask:0xf
    s_waitcnt lgkmcnt(10)
    v_mfma_f32_32x32x16_bf16 v[176:191], v[24:27], v[148:151], v[176:191]
    ds_read_b64_tr_b16 v[236:237], v20 offset:28672
    ds_read_b64_tr_b16 v[238:239], v20 offset:30720
    v_cndmask_b32_dpp v69, v253, v245, vcc row_ror:8 row_mask:0xf bank_mask:0xf
    v_cndmask_b32_dpp v73, v254, v246, vcc row_ror:8 row_mask:0xf bank_mask:0xf
    v_cndmask_b32_dpp v77, v255, v247, vcc row_ror:8 row_mask:0xf bank_mask:0xf
    s_add_u32 s98, s59, 114688
    buffer_load_dwordx4 v[96:99], v15, s[28:31], s98 offen offset:0
    s_waitcnt lgkmcnt(10)
    v_mfma_f32_32x32x16_bf16 v[192:207], v[4:7], v[148:151], v[192:207]
    ds_read_b64_tr_b16 v[24:25], v17 offset:29696
    ds_read_b64_tr_b16 v[26:27], v17 offset:31744
    s_waitcnt lgkmcnt(10)
    v_mfma_f32_32x32x16_bf16 v[208:223], v[8:11], v[148:151], v[208:223]
    ds_read_b64_tr_b16 v[4:5], v18 offset:29696
    ds_read_b64_tr_b16 v[6:7], v18 offset:31744
    buffer_load_dwordx4 v[148:151], v16, s[36:39], s60 offen offset:1024 sc1
    s_waitcnt vmcnt(14)
    s_waitcnt lgkmcnt(10)
    v_mfma_f32_32x32x16_bf16 v[160:175], v[224:227], v[152:155], v[160:175]
    ds_read_b64_tr_b16 v[8:9], v19 offset:29696
    ds_read_b64_tr_b16 v[10:11], v19 offset:31744
    v_lshlrev_b32 v13, 2, v1
    s_add_u32 s62, s62, 512
    s_mov_b64 exec, 0x3fff
    buffer_load_dword v12, v13, s[36:39], s62 offen sc1
    s_mov_b64 exec, -1
    s_waitcnt lgkmcnt(10)
    s_nop 4
    v_mfma_f32_32x32x16_bf16 v[176:191], v[228:231], v[152:155], v[176:191]
    ds_read_b64_tr_b16 v[224:225], v20 offset:29696
    ds_read_b64_tr_b16 v[226:227], v20 offset:31744
    buffer_load_dwordx4 v[100:103], v15, s[28:31], s98 offen offset:896
    s_waitcnt lgkmcnt(10)
    v_mfma_f32_32x32x16_bf16 v[192:207], v[232:235], v[152:155], v[192:207]
    ds_read_b64_tr_b16 v[228:229], v17 offset:32768
    ds_read_b64_tr_b16 v[230:231], v17 offset:34816
    s_waitcnt lgkmcnt(10)
    v_mfma_f32_32x32x16_bf16 v[208:223], v[236:239], v[152:155], v[208:223]
    ds_read_b64_tr_b16 v[232:233], v18 offset:32768
    ds_read_b64_tr_b16 v[234:235], v18 offset:34816
    buffer_load_dwordx4 v[152:155], v16, s[36:39], s60 offen offset:2048 sc1
    s_waitcnt vmcnt(15)
    s_waitcnt lgkmcnt(10)
    v_mfma_f32_32x32x16_bf16 v[160:175], v[24:27], v[156:159], v[160:175]
    ds_read_b64_tr_b16 v[236:237], v19 offset:32768
    ds_read_b64_tr_b16 v[238:239], v19 offset:34816
    s_waitcnt lgkmcnt(10)
    v_mfma_f32_32x32x16_bf16 v[176:191], v[4:7], v[156:159], v[176:191]
    ds_read_b64_tr_b16 v[24:25], v20 offset:32768
    ds_read_b64_tr_b16 v[26:27], v20 offset:34816
    buffer_load_dwordx4 v[104:107], v15, s[28:31], s98 offen offset:1792
    s_waitcnt lgkmcnt(10)
    v_mfma_f32_32x32x16_bf16 v[192:207], v[8:11], v[156:159], v[192:207]
    ds_read_b64_tr_b16 v[4:5], v17 offset:33792
    ds_read_b64_tr_b16 v[6:7], v17 offset:35840
    s_waitcnt lgkmcnt(10)
    v_mfma_f32_32x32x16_bf16 v[208:223], v[224:227], v[156:159], v[208:223]
    ds_read_b64_tr_b16 v[8:9], v18 offset:33792
    ds_read_b64_tr_b16 v[10:11], v18 offset:35840
    buffer_load_dwordx4 v[156:159], v16, s[36:39], s60 offen offset:3072 sc1
    s_add_u32 s60, s60, 4096
    s_waitcnt vmcnt(15)
    s_waitcnt lgkmcnt(10)
    v_mfma_f32_32x32x16_bf16 v[160:175], v[228:231], v[128:131], v[160:175]
    ds_read_b64_tr_b16 v[224:225], v19 offset:33792
    ds_read_b64_tr_b16 v[226:227], v19 offset:35840
    s_waitcnt lgkmcnt(10)
    v_mfma_f32_32x32x16_bf16 v[176:191], v[232:235], v[128:131], v[176:191]
    ds_read_b64_tr_b16 v[228:229], v20 offset:33792
    ds_read_b64_tr_b16 v[230:231], v20 offset:35840
    buffer_load_dwordx4 v[108:111], v15, s[28:31], s98 offen offset:2688
    s_waitcnt lgkmcnt(10)
    v_mfma_f32_32x32x16_bf16 v[192:207], v[236:239], v[128:131], v[192:207]
    ds_read_b64_tr_b16 v[232:233], v17 offset:36864
    ds_read_b64_tr_b16 v[234:235], v17 offset:38912
    s_waitcnt lgkmcnt(10)
    v_mfma_f32_32x32x16_bf16 v[208:223], v[24:27], v[128:131], v[208:223]
    ds_read_b64_tr_b16 v[236:237], v18 offset:36864
    ds_read_b64_tr_b16 v[238:239], v18 offset:38912
    buffer_load_dwordx4 v[128:131], v16, s[36:39], s60 offen offset:0 sc1
    s_waitcnt vmcnt(15)
    s_waitcnt lgkmcnt(10)
    v_mfma_f32_32x32x16_bf16 v[160:175], v[4:7], v[132:135], v[160:175]
    ds_read_b64_tr_b16 v[24:25], v19 offset:36864
    ds_read_b64_tr_b16 v[26:27], v19 offset:38912
    s_waitcnt vmcnt(6)
    s_mov_b32 s78, 0
L_sf_31:
    v_cmp_ne_u32 s[90:91], s53, v12
    s_nop 0
    s_and_b32 s90, s90, 0x3fff
    s_cbranch_scc1 L_sfre_32
L_sfok_33:
    v_mov_b32 v252, 0
    v_mov_b32 v253, 0
    v_mov_b32 v254, 0
    v_mov_b32 v255, 0
    buffer_load_dwordx4 v[240:243], v21, s[36:39], s63 offen offset:0 sc1
    buffer_load_dwordx4 v[244:247], v21, s[36:39], s63 offen offset:512 sc1
    buffer_load_dwordx4 v[248:251], v21, s[36:39], s63 offen offset:1024 sc1
    s_mov_b64 exec, 0xffffffff
    buffer_load_dwordx4 v[252:255], v21, s[36:39], s63 offen offset:1536 sc1
    s_mov_b64 exec, -1
    s_waitcnt lgkmcnt(10)
    s_nop 4
    v_mfma_f32_32x32x16_bf16 v[176:191], v[8:11], v[132:135], v[176:191]
    ds_read_b64_tr_b16 v[4:5], v20 offset:36864
    ds_read_b64_tr_b16 v[6:7], v20 offset:38912
    s_add_u32 s98, s59, 143360
    buffer_load_dwordx4 v[112:115], v15, s[28:31], s98 offen offset:0
    s_waitcnt lgkmcnt(10)
    v_mfma_f32_32x32x16_bf16 v[192:207], v[224:227], v[132:135], v[192:207]
    ds_read_b64_tr_b16 v[8:9], v17 offset:37888
    ds_read_b64_tr_b16 v[10:11], v17 offset:39936
    s_waitcnt lgkmcnt(10)
    v_mfma_f32_32x32x16_bf16 v[208:223], v[228:231], v[132:135], v[208:223]
    ds_read_b64_tr_b16 v[224:225], v18 offset:37888
    ds_read_b64_tr_b16 v[226:227], v18 offset:39936
    buffer_load_dwordx4 v[132:135], v16, s[36:39], s60 offen offset:1024 sc1
    s_waitcnt vmcnt(19)
    s_waitcnt lgkmcnt(10)
    v_mfma_f32_32x32x16_bf16 v[160:175], v[232:235], v[136:139], v[160:175]
    ds_read_b64_tr_b16 v[228:229], v19 offset:37888
    ds_read_b64_tr_b16 v[230:231], v19 offset:39936
    s_waitcnt lgkmcnt(10)
    v_mfma_f32_32x32x16_bf16 v[176:191], v[236:239], v[136:139], v[176:191]
    ds_read_b64_tr_b16 v[232:233], v20 offset:37888
    ds_read_b64_tr_b16 v[234:235], v20 offset:39936
    buffer_load_dwordx4 v[116:119], v15, s[28:31], s98 offen offset:896
    s_waitcnt lgkmcnt(10)
    v_mfma_f32_32x32x16_bf16 v[192:207], v[24:27], v[136:139], v[192:207]
    ds_read_b64_tr_b16 v[236:237], v17 offset:40960
    ds_read_b64_tr_b16 v[238:239], v17 offset:43008
    s_waitcnt lgkmcnt(10)
    v_mfma_f32_32x32x16_bf16 v[208:223], v[4:7], v[136:139], v[208:223]
    ds_read_b64_tr_b16 v[24:25], v17 offset:41984
    ds_read_b64_tr_b16 v[26:27], v17 offset:44032
    s_waitcnt vmcnt(3)
    v_add_f32 v240, v240, v242
    v_add_f32 v241, v241, v243
    v_add_f32 v244, v244, v246
    v_add_f32 v245, v245, v247
    buffer_load_dwordx4 v[136:139], v16, s[36:39], s60 offen offset:2048 sc1
    s_waitcnt vmcnt(19)
    s_waitcnt lgkmcnt(10)
    v_mfma_f32_32x32x16_bf16 v[160:175], v[8:11], v[140:143], v[160:175]
    ds_read_b64_tr_b16 v[4:5], v17 offset:45056
    ds_read_b64_tr_b16 v[6:7], v17 offset:47104
    v_add_f32 v248, v248, v250
    v_add_f32 v249, v249, v251
    v_add_f32 v252, v252, v254
    v_add_f32 v253, v253, v255
    s_waitcnt lgkmcnt(10)
    v_mfma_f32_32x32x16_bf16 v[176:191], v[224:227], v[140:143], v[176:191]
    ds_read_b64_tr_b16 v[8:9], v17 offset:46080
    ds_read_b64_tr_b16 v[10:11], v17 offset:48128
    v_add_f32 v240, v240, v244
    v_add_f32 v241, v241, v245
    v_add_f32 v248, v248, v252
    v_add_f32 v249, v249, v253
    buffer_load_dwordx4 v[120:123], v15, s[28:31], s98 offen offset:1792
    s_waitcnt lgkmcnt(10)
    v_mfma_f32_32x32x16_bf16 v[192:207], v[228:231], v[140:143], v[192:207]
    ds_read_b64_tr_b16 v[224:225], v17 offset:49152
    ds_read_b64_tr_b16 v[226:227], v17 offset:51200
    v_add_f32 v28, v240, v248
    v_add_f32 v29, v241, v249
    v_mov_b32 v12, v28
    v_mov_b32 v13, v29
    s_waitcnt lgkmcnt(10)
    v_mfma_f32_32x32x16_bf16 v[208:223], v[232:235], v[140:143], v[208:223]
    ds_read_b64_tr_b16 v[228:229], v17 offset:50176
    ds_read_b64_tr_b16 v[230:231], v17 offset:52224
    v_permlane32_swap_b32 v28, v12
    v_permlane32_swap_b32 v29, v13
    v_add_f32 v28, v28, v12
    v_add_f32 v29, v29, v13
    buffer_load_dwordx4 v[140:143], v16, s[36:39], s60 offen offset:3072 sc1
    s_add_u32 s60, s60, 4096
    s_waitcnt vmcnt(19)
    s_waitcnt lgkmcnt(10)
    v_mfma_f32_32x32x16_bf16 v[160:175], v[236:239], v[144:147], v[160:175]
    ds_read_b64_tr_b16 v[232:233], v17 offset:53248
    ds_read_b64_tr_b16 v[234:235], v17 offset:55296
    v_mul_f32 v28, 0xbb124925, v28
    v_mul_f32 v29, 0x3b124925, v29
    v_fma_f32 v29, -v28, v28, v29
    v_max_f32 v29, 0, v29
    s_waitcnt vmcnt(17)
    s_waitcnt lgkmcnt(10)
    v_mfma_f32_32x32x16_bf16 v[160:175], v[24:27], v[148:151], v[160:175]
    ds_read_b64_tr_b16 v[236:237], v17 offset:54272
    ds_read_b64_tr_b16 v[238:239], v17 offset:56320
    v_cvt_pk_bf16_f32 v29, v29, v29
    v_lshlrev_b32 v29, 16, v29
    v_add_f32 v29, 0x3727c5ac, v29
    v_cvt_pk_bf16_f32 v29, v29, v29
    buffer_load_dwordx4 v[124:127], v15, s[28:31], s98 offen offset:2688
    s_waitcnt vmcnt(15)
    s_waitcnt lgkmcnt(10)
    v_mfma_f32_32x32x16_bf16 v[160:175], v[4:7], v[152:155], v[160:175]
    ds_read_b64_tr_b16 v[24:25], v18 offset:40960
    ds_read_b64_tr_b16 v[26:27], v18 offset:43008
    v_lshlrev_b32 v29, 16, v29
    v_sqrt_f32 v29, v29
    v_cvt_pk_bf16_f32 v28, v28, v28
    v_lshlrev_b32 v28, 16, v28
    s_waitcnt vmcnt(13)
    s_waitcnt lgkmcnt(10)
    v_mfma_f32_32x32x16_bf16 v[160:175], v[8:11], v[156:159], v[160:175]
    ds_read_b64_tr_b16 v[4:5], v18 offset:41984
    ds_read_b64_tr_b16 v[6:7], v18 offset:44032
    v_cvt_pk_bf16_f32 v29, v29, v29
    v_lshlrev_b32 v29, 16, v29
    v_rcp_f32 v30, v29
    s_nop 0
    v_mul_f32 v30, 0xbfb8aa3b, v30
    s_waitcnt vmcnt(11)
    s_waitcnt lgkmcnt(10)
    v_mfma_f32_32x32x16_bf16 v[160:175], v[224:227], v[128:131], v[160:175]
    ds_read_b64_tr_b16 v[8:9], v18 offset:45056
    ds_read_b64_tr_b16 v[10:11], v18 offset:47104
    ds_read_b128 v[240:243], v23 offset:0
    ds_read_b128 v[244:247], v23 offset:32
    s_waitcnt vmcnt(5)
    s_waitcnt lgkmcnt(12)
    v_mfma_f32_32x32x16_bf16 v[160:175], v[228:231], v[132:135], v[160:175]
    ds_read_b64_tr_b16 v[224:225], v18 offset:46080
    ds_read_b64_tr_b16 v[226:227], v18 offset:48128
    s_waitcnt vmcnt(3)
    s_waitcnt lgkmcnt(12)
    v_mfma_f32_32x32x16_bf16 v[160:175], v[232:235], v[136:139], v[160:175]
    ds_read_b64_tr_b16 v[228:229], v18 offset:49152
    ds_read_b64_tr_b16 v[230:231], v18 offset:51200
    s_waitcnt vmcnt(1)
    s_waitcnt lgkmcnt(12)
    v_mfma_f32_32x32x16_bf16 v[160:175], v[236:239], v[140:143], v[160:175]
    ds_read_b64_tr_b16 v[232:233], v18 offset:50176
    ds_read_b64_tr_b16 v[234:235], v18 offset:52224
    s_waitcnt lgkmcnt(12)
    v_mfma_f32_32x32x16_bf16 v[176:191], v[24:27], v[144:147], v[176:191]
    ds_read_b64_tr_b16 v[236:237], v18 offset:53248
    ds_read_b64_tr_b16 v[238:239], v18 offset:55296
    s_waitcnt lgkmcnt(12)
    v_mfma_f32_32x32x16_bf16 v[176:191], v[4:7], v[148:151], v[176:191]
    ds_read_b64_tr_b16 v[24:25], v18 offset:54272
    ds_read_b64_tr_b16 v[26:27], v18 offset:56320
    s_waitcnt lgkmcnt(10)
    s_nop 0
    v_fmac_f32 v160, v28, v240
    v_fmac_f32 v161, v28, v241
    v_fmac_f32 v162, v28, v242
    v_fmac_f32 v163, v28, v243
    v_fmac_f32 v164, v28, v244
    v_fmac_f32 v165, v28, v245
    v_fmac_f32 v166, v28, v246
    v_fmac_f32 v167, v28, v247
    v_mfma_f32_32x32x16_bf16 v[176:191], v[8:11], v[152:155], v[176:191]
    ds_read_b64_tr_b16 v[4:5], v19 offset:40960
    ds_read_b64_tr_b16 v[6:7], v19 offset:43008
    ds_read_b128 v[240:243], v23 offset:64
    ds_read_b128 v[244:247], v23 offset:96
    v_mul_f32 v160, v30, v160
    v_mul_f32 v161, v30, v161
    v_mul_f32 v162, v30, v162
    v_mul_f32 v163, v30, v163
    v_mul_f32 v164, v30, v164
    v_mul_f32 v165, v30, v165
    v_mul_f32 v166, v30, v166
    s_waitcnt lgkmcnt(12)
    v_mfma_f32_32x32x16_bf16 v[176:191], v[224:227], v[156:159], v[176:191]
    ds_read_b64_tr_b16 v[8:9], v19 offset:41984
    ds_read_b64_tr_b16 v[10:11], v19 offset:44032
    v_mul_f32 v167, v30, v167
    v_exp_f32 v160, v160
    v_exp_f32 v161, v161
    v_exp_f32 v162, v162
    v_exp_f32 v163, v163
    v_exp_f32 v164, v164
    v_exp_f32 v165, v165
    v_exp_f32 v166, v166
    v_exp_f32 v167, v167
    s_waitcnt lgkmcnt(12)
    v_mfma_f32_32x32x16_bf16 v[176:191], v[228:231], v[128:131], v[176:191]
    ds_read_b64_tr_b16 v[224:225], v19 offset:45056
    ds_read_b64_tr_b16 v[226:227], v19 offset:47104
    s_waitcnt lgkmcnt(4)
    v_fmac_f32 v168, v28, v240
    v_fmac_f32 v169, v28, v241
    v_fmac_f32 v170, v28, v242
    v_fmac_f32 v171, v28, v243
    v_fmac_f32 v172, v28, v244
    v_fmac_f32 v173, v28, v245
    v_fmac_f32 v174, v28, v246
    v_mfma_f32_32x32x16_bf16 v[176:191], v[232:235], v[132:135], v[176:191]
    ds_read_b64_tr_b16 v[228:229], v19 offset:46080
    ds_read_b64_tr_b16 v[230:231], v19 offset:48128
    v_fmac_f32 v175, v28, v247
    ds_read_b128 v[240:243], v23 offset:128
    ds_read_b128 v[244:247], v23 offset:160
    v_fma_f32 v160, v160, v29, v29
    v_fma_f32 v161, v161, v29, v29
    v_fma_f32 v162, v162, v29, v29
    v_fma_f32 v163, v163, v29, v29
    v_fma_f32 v164, v164, v29, v29
    v_mfma_f32_32x32x16_bf16 v[176:191], v[236:239], v[136:139], v[176:191]
    ds_read_b64_tr_b16 v[232:233], v19 offset:49152
    ds_read_b64_tr_b16 v[234:235], v19 offset:51200
    v_fma_f32 v165, v165, v29, v29
    v_fma_f32 v166, v166, v29, v29
    v_fma_f32 v167, v167, v29, v29
    v_rcp_f32 v160, v160
    v_rcp_f32 v161, v161
    v_rcp_f32 v162, v162
    v_rcp_f32 v163, v163
    v_rcp_f32 v164, v164
    v_mfma_f32_32x32x16_bf16 v[176:191], v[24:27], v[140:143], v[176:191]
    ds_read_b64_tr_b16 v[236:237], v19 offset:50176
    ds_read_b64_tr_b16 v[238:239], v19 offset:52224
    v_rcp_f32 v165, v165
    v_rcp_f32 v166, v166
    v_rcp_f32 v167, v167
    v_mul_f32 v168, v160, v168
    v_mul_f32 v169, v161, v169
    v_mul_f32 v170, v162, v170
    v_mul_f32 v171, v163, v171
    v_mul_f32 v172, v164, v172
    v_mfma_f32_32x32x16_bf16 v[192:207], v[4:7], v[144:147], v[192:207]
    ds_read_b64_tr_b16 v[24:25], v19 offset:53248
    ds_read_b64_tr_b16 v[26:27], v19 offset:55296
    v_mul_f32 v173, v165, v173
    v_mul_f32 v174, v166, v174
    v_mul_f32 v175, v167, v175
    v_cvt_pk_bf16_f32 v160, v168, v169
    v_cvt_pk_bf16_f32 v161, v170, v171
    v_cvt_pk_bf16_f32 v162, v172, v173
    v_cvt_pk_bf16_f32 v163, v174, v175
    buffer_store_dwordx4 v[160:163], v22, s[36:39], s84 offen offset:0 sc1
    s_waitcnt lgkmcnt(12)
    v_mfma_f32_32x32x16_bf16 v[192:207], v[8:11], v[148:151], v[192:207]
    ds_read_b64_tr_b16 v[4:5], v19 offset:54272
    ds_read_b64_tr_b16 v[6:7], v19 offset:56320
    s_waitcnt lgkmcnt(8)
    v_fmac_f32 v176, v28, v240
    v_fmac_f32 v177, v28, v241
    v_fmac_f32 v178, v28, v242
    v_fmac_f32 v179, v28, v243
    v_fmac_f32 v180, v28, v244
    v_fmac_f32 v181, v28, v245
    v_fmac_f32 v182, v28, v246
    v_fmac_f32 v183, v28, v247
    v_mfma_f32_32x32x16_bf16 v[192:207], v[224:227], v[152:155], v[192:207]
    ds_read_b64_tr_b16 v[8:9], v20 offset:40960
    ds_read_b64_tr_b16 v[10:11], v20 offset:43008
    ds_read_b128 v[240:243], v23 offset:192
    ds_read_b128 v[244:247], v23 offset:224
    v_mul_f32 v176, v30, v176
    v_mul_f32 v177, v30, v177
    v_mul_f32 v178, v30, v178
    v_mul_f32 v179, v30, v179
    v_mul_f32 v180, v30, v180
    v_mul_f32 v181, v30, v181
    v_mul_f32 v182, v30, v182
    v_mfma_f32_32x32x16_bf16 v[192:207], v[228:231], v[156:159], v[192:207]
    ds_read_b64_tr_b16 v[224:225], v20 offset:41984
    ds_read_b64_tr_b16 v[226:227], v20 offset:44032
    v_mul_f32 v183, v30, v183
    v_exp_f32 v176, v176
    v_exp_f32 v177, v177
    v_exp_f32 v178, v178
    v_exp_f32 v179, v179
    v_exp_f32 v180, v180
    v_exp_f32 v181, v181
    v_exp_f32 v182, v182
    v_exp_f32 v183, v183
    s_waitcnt lgkmcnt(12)
    v_mfma_f32_32x32x16_bf16 v[192:207], v[232:235], v[128:131], v[192:207]
    ds_read_b64_tr_b16 v[228:229], v20 offset:45056
    ds_read_b64_tr_b16 v[230:231], v20 offset:47104
    s_waitcnt lgkmcnt(4)
    v_fmac_f32 v184, v28, v240
    v_fmac_f32 v185, v28, v241
    v_fmac_f32 v186, v28, v242
    v_fmac_f32 v187, v28, v243
    v_fmac_f32 v188, v28, v244
    v_fmac_f32 v189, v28, v245
    v_fmac_f32 v190, v28, v246
    v_mfma_f32_32x32x16_bf16 v[192:207], v[236:239], v[132:135], v[192:207]
    ds_read_b64_tr_b16 v[232:233], v20 offset:46080
    ds_read_b64_tr_b16 v[234:235], v20 offset:48128
    v_fmac_f32 v191, v28, v247
    ds_read_b128 v[240:243], v23 offset:256
    ds_read_b128 v[244:247], v23 offset:288
    v_fma_f32 v176, v176, v29, v29
    v_fma_f32 v177, v177, v29, v29
    v_fma_f32 v178, v178, v29, v29
    v_fma_f32 v179, v179, v29, v29
    v_fma_f32 v180, v180, v29, v29
    v_mfma_f32_32x32x16_bf16 v[192:207], v[24:27], v[136:139], v[192:207]
    ds_read_b64_tr_b16 v[236:237], v20 offset:49152
    ds_read_b64_tr_b16 v[238:239], v20 offset:51200
    v_fma_f32 v181, v181, v29, v29
    v_fma_f32 v182, v182, v29, v29
    v_fma_f32 v183, v183, v29, v29
    v_rcp_f32 v176, v176
    v_rcp_f32 v177, v177
    v_rcp_f32 v178, v178
    v_rcp_f32 v179, v179
    v_rcp_f32 v180, v180
    v_mfma_f32_32x32x16_bf16 v[192:207], v[4:7], v[140:143], v[192:207]
    ds_read_b64_tr_b16 v[24:25], v20 offset:50176
    ds_read_b64_tr_b16 v[26:27], v20 offset:52224
    v_rcp_f32 v181, v181
    v_rcp_f32 v182, v182
    v_rcp_f32 v183, v183
    v_mul_f32 v184, v176, v184
    v_mul_f32 v185, v177, v185
    v_mul_f32 v186, v178, v186
    v_mul_f32 v187, v179, v187
    v_mul_f32 v188, v180, v188
    v_mfma_f32_32x32x16_bf16 v[208:223], v[8:11], v[144:147], v[208:223]
    ds_read_b64_tr_b16 v[4:5], v20 offset:53248
    ds_read_b64_tr_b16 v[6:7], v20 offset:55296
    v_mul_f32 v189, v181, v189
    v_mul_f32 v190, v182, v190
    v_mul_f32 v191, v183, v191
    v_cvt_pk_bf16_f32 v176, v184, v185
    v_cvt_pk_bf16_f32 v177, v186, v187
    v_cvt_pk_bf16_f32 v178, v188, v189
    v_cvt_pk_bf16_f32 v179, v190, v191
    buffer_store_dwordx4 v[176:179], v22, s[36:39], s84 offen offset:512 sc1
    s_waitcnt lgkmcnt(12)
    v_mfma_f32_32x32x16_bf16 v[208:223], v[224:227], v[148:151], v[208:223]
    ds_read_b64_tr_b16 v[8:9], v20 offset:54272
    ds_read_b64_tr_b16 v[10:11], v20 offset:56320
    s_waitcnt lgkmcnt(8)
    v_fmac_f32 v192, v28, v240
    v_fmac_f32 v193, v28, v241
    v_fmac_f32 v194, v28, v242
    v_fmac_f32 v195, v28, v243
    v_fmac_f32 v196, v28, v244
    v_fmac_f32 v197, v28, v245
    v_fmac_f32 v198, v28, v246
    v_fmac_f32 v199, v28, v247
    ds_read_b128 v[240:243], v23 offset:320
    v_mfma_f32_32x32x16_bf16 v[208:223], v[228:231], v[152:155], v[208:223]
    ds_read_b128 v[244:247], v23 offset:352
    v_mul_f32 v192, v30, v192
    v_mul_f32 v193, v30, v193
    v_mul_f32 v194, v30, v194
    v_mul_f32 v195, v30, v195
    v_mul_f32 v196, v30, v196
    v_mul_f32 v197, v30, v197
    v_mul_f32 v198, v30, v198
    v_mul_f32 v199, v30, v199
    v_exp_f32 v192, v192
    v_mfma_f32_32x32x16_bf16 v[208:223], v[232:235], v[156:159], v[208:223]
    v_exp_f32 v193, v193
    v_exp_f32 v194, v194
    v_exp_f32 v195, v195
    v_exp_f32 v196, v196
    v_exp_f32 v197, v197
    v_exp_f32 v198, v198
    v_exp_f32 v199, v199
    s_waitcnt lgkmcnt(0)
    v_fmac_f32 v200, v28, v240
    v_fmac_f32 v201, v28, v241
    v_mfma_f32_32x32x16_bf16 v[208:223], v[236:239], v[128:131], v[208:223]
    v_fmac_f32 v202, v28, v242
    v_fmac_f32 v203, v28, v243
    v_fmac_f32 v204, v28, v244
    v_fmac_f32 v205, v28, v245
    v_fmac_f32 v206, v28, v246
    v_fmac_f32 v207, v28, v247
    ds_read_b128 v[240:243], v23 offset:384
    ds_read_b128 v[244:247], v23 offset:416
    v_fma_f32 v192, v192, v29, v29
    v_fma_f32 v193, v193, v29, v29
    v_mfma_f32_32x32x16_bf16 v[208:223], v[24:27], v[132:135], v[208:223]
    v_fma_f32 v194, v194, v29, v29
    v_fma_f32 v195, v195, v29, v29
    v_fma_f32 v196, v196, v29, v29
    v_fma_f32 v197, v197, v29, v29
    v_fma_f32 v198, v198, v29, v29
    v_fma_f32 v199, v199, v29, v29
    v_rcp_f32 v192, v192
    v_rcp_f32 v193, v193
    v_rcp_f32 v194, v194
    v_mfma_f32_32x32x16_bf16 v[208:223], v[4:7], v[136:139], v[208:223]
    v_rcp_f32 v195, v195
    v_rcp_f32 v196, v196
    v_rcp_f32 v197, v197
    v_rcp_f32 v198, v198
    v_rcp_f32 v199, v199
    v_mul_f32 v200, v192, v200
    v_mul_f32 v201, v193, v201
    v_mul_f32 v202, v194, v202
    v_mul_f32 v203, v195, v203
    v_mfma_f32_32x32x16_bf16 v[208:223], v[8:11], v[140:143], v[208:223]
    v_mul_f32 v204, v196, v204
    v_mul_f32 v205, v197, v205
    v_mul_f32 v206, v198, v206
    v_mul_f32 v207, v199, v207
    v_cvt_pk_bf16_f32 v192, v200, v201
    v_cvt_pk_bf16_f32 v193, v202, v203
    v_cvt_pk_bf16_f32 v194, v204, v205
    v_cvt_pk_bf16_f32 v195, v206, v207
    buffer_store_dwordx4 v[192:195], v22, s[36:39], s84 offen offset:1024 sc1
    s_add_u32 s98, s59, 172032
    buffer_load_dwordx4 v[128:131], v15, s[28:31], s98 offen offset:0
    buffer_load_dwordx4 v[132:135], v15, s[28:31], s98 offen offset:896
    buffer_load_dwordx4 v[136:139], v15, s[28:31], s98 offen offset:1792
    buffer_load_dwordx4 v[140:143], v15, s[28:31], s98 offen offset:2688
    s_waitcnt lgkmcnt(0)
    v_fmac_f32 v208, v28, v240
    v_fmac_f32 v209, v28, v241
    v_fmac_f32 v210, v28, v242
    v_fmac_f32 v211, v28, v243
    v_fmac_f32 v212, v28, v244
    v_fmac_f32 v213, v28, v245
    v_fmac_f32 v214, v28, v246
    v_fmac_f32 v215, v28, v247
    ds_read_b128 v[240:243], v23 offset:448
    ds_read_b128 v[244:247], v23 offset:480
    v_mul_f32 v208, v30, v208
    v_mul_f32 v209, v30, v209
    v_mul_f32 v210, v30, v210
    v_mul_f32 v211, v30, v211
    v_mul_f32 v212, v30, v212
    v_mul_f32 v213, v30, v213
    v_mul_f32 v214, v30, v214
    v_mul_f32 v215, v30, v215
    v_exp_f32 v208, v208
    v_exp_f32 v209, v209
    v_exp_f32 v210, v210
    v_exp_f32 v211, v211
    v_exp_f32 v212, v212
    v_exp_f32 v213, v213
    v_exp_f32 v214, v214
    v_exp_f32 v215, v215
    s_waitcnt lgkmcnt(0)
    v_mov_b32 v25, 162816
    v_mov_b32 v26, 1
    s_waitcnt lgkmcnt(0)
    s_mov_b64 exec, 1
    ds_add_u32 v25, v26
    s_mov_b64 exec, -1
    v_fmac_f32 v216, v28, v240
    v_fmac_f32 v217, v28, v241
    v_fmac_f32 v218, v28, v242
    v_fmac_f32 v219, v28, v243
    v_fmac_f32 v220, v28, v244
    v_fmac_f32 v221, v28, v245
    v_fmac_f32 v222, v28, v246
    v_fmac_f32 v223, v28, v247
    v_fma_f32 v208, v208, v29, v29
    v_fma_f32 v209, v209, v29, v29
    v_fma_f32 v210, v210, v29, v29
    v_fma_f32 v211, v211, v29, v29
    v_fma_f32 v212, v212, v29, v29
    v_fma_f32 v213, v213, v29, v29
    v_fma_f32 v214, v214, v29, v29
    v_fma_f32 v215, v215, v29, v29
    v_rcp_f32 v208, v208
    v_rcp_f32 v209, v209
    v_rcp_f32 v210, v210
    v_rcp_f32 v211, v211
    v_rcp_f32 v212, v212
    v_rcp_f32 v213, v213
    v_rcp_f32 v214, v214
    v_rcp_f32 v215, v215
    v_mul_f32 v216, v208, v216
    v_mul_f32 v217, v209, v217
    v_mul_f32 v218, v210, v218
    v_mul_f32 v219, v211, v219
    v_mul_f32 v220, v212, v220
    v_mul_f32 v221, v213, v221
    v_mul_f32 v222, v214, v222
    v_mul_f32 v223, v215, v223
    v_cvt_pk_bf16_f32 v208, v216, v217
    v_cvt_pk_bf16_f32 v209, v218, v219
    v_cvt_pk_bf16_f32 v210, v220, v221
    v_cvt_pk_bf16_f32 v211, v222, v223
    buffer_store_dwordx4 v[208:211], v22, s[36:39], s84 offen offset:1536 sc1
    s_setprio 0
    s_cmp_lt_u32 s4, 4
    s_cbranch_scc1 L_pr_34
    s_setprio 1
L_pr_34:
    s_mul_i32 s60, s4, 7
    s_lshr_b32 s61, s60, 1
    s_lshl_b32 s61, s61, 2
    s_lshl_b32 s62, s51, 7
    s_add_u32 s61, s61, s62
    s_add_u32 s61, s61, s54
    s_add_u32 s65, s61, 3072
    s_lshl_b32 s64, s5, 3
    s_add_u32 s64, s64, s51
    s_mul_i32 s61, s64, 112
    s_add_u32 s61, s61, s60
    s_lshl_b32 s61, s61, 10
    s_add_u32 s59, s61, 2097152
    s_lshl_b32 s61, s46, 2
    s_add_u32 s61, s61, s64
    s_mul_i32 s62, s61, 28
    s_lshl_b32 s60, s52, 2
    s_add_u32 s62, s62, s60
    s_and_b32 s60, s4, 3
    s_add_u32 s62, s62, s60
    s_lshl_b32 s57, s62, 10
    s_lshl_b32 s61, s61, 1
    s_and_b32 s60, s44, 1
    s_add_u32 s64, s61, s60
    v_lshlrev_b32 v5, 2, v1
    s_lshl_b32 s63, s4, 11
    s_add_u32 s63, s63, 0
    v_lshl_add_u32 v18, v1, 3, s63
    v_add_u32 v19, 65536, v18
    v_lshrrev_b32 v4, 1, v2
    v_and_b32 v6, 1, v2
    v_lshl_add_u32 v7, v6, 3, v4
    v_lshl_add_u32 v7, v3, 4, v7
    s_lshl_b32 s63, s4, 14
    s_add_u32 s63, s63, 0
    v_lshl_add_u32 v20, v7, 3, s63
    v_lshl_add_u32 v7, v3, 1, s45
    v_lshrrev_b32 v4, 3, v2
    v_lshlrev_b32 v4, 11, v4
    v_and_b32 v6, 3, v2
    v_lshl_add_u32 v4, v6, 9, v4
    v_bfe_u32 v6, v2, 2, 1
    v_lshl_add_u32 v4, v6, 3, v4
    v_lshl_add_u32 v4, v7, 5, v4
    s_lshl_b32 s63, s46, 12
    s_and_b32 s60, s44, 1
    s_lshl_b32 s60, s60, 8
    s_add_u32 s63, s63, s60
    s_add_u32 s63, s63, 149632
    v_add_u32 v17, s63, v4
    v_mul_u32_u24 v21, 1792, v7
    v_lshl_add_u32 v21, v2, 3, v21
    s_mul_i32 s63, s64, 14336
    s_lshl_b32 s60, s52, 7
    s_add_u32 s63, s63, s60
    v_mov_b32 v12, s53
    v_mov_b32 v13, 0
    s_waitcnt vmcnt(0)
    s_mov_b64 exec, 1
    s_cmp_eq_u32 s7, 0
    s_cbranch_scc1 L_slow_35
    buffer_store_dword v12, v13, s[36:39], s85 offen
L_back_36:
    s_mov_b64 exec, -1
    s_mov_b32 exec_lo, 0xf
    s_mov_b32 exec_hi, 0x0
    s_mov_b32 s78, 0
L_poll_37:
    buffer_load_dword v4, v5, s[36:39], s65 offen sc1
    s_add_u32 s78, s78, 1
    s_cmp_ge_u32 s78, 200000
    s_cbranch_scc1 L_pollend_38
    s_waitcnt vmcnt(0)
    v_cmp_ne_u32 vcc, s53, v4
    s_nop 1
    s_cbranch_vccz L_pollend_38
    s_sleep 2
    s_branch L_poll_37
L_pollend_38:
    s_waitcnt vmcnt(0)
    s_mov_b64 exec, -1
    s_add_u32 s96, s59, 0
    buffer_load_dwordx4 v[144:147], v16, s[36:39], s96 offen sc1
    s_add_u32 s96, s59, 1024
    buffer_load_dwordx4 v[148:151], v16, s[36:39], s96 offen sc1
    s_add_u32 s96, s59, 2048
    buffer_load_dwordx4 v[152:155], v16, s[36:39], s96 offen sc1
    s_add_u32 s96, s59, 3072
    buffer_load_dwordx4 v[156:159], v16, s[36:39], s96 offen sc1
    s_add_u32 s96, s59, 4096
    buffer_load_dwordx4 v[224:227], v16, s[36:39], s96 offen sc1
    s_add_u32 s96, s59, 5120
    buffer_load_dwordx4 v[228:231], v16, s[36:39], s96 offen sc1
    s_add_u32 s96, s59, 6144
    buffer_load_dwordx4 v[232:235], v16, s[36:39], s96 offen sc1
    s_add_u32 s96, s59, 57344
    buffer_load_dwordx4 v[236:239], v16, s[36:39], s96 offen sc1
    v_perm_b32 v240, v84, v80, s76
    v_perm_b32 v248, v86, v82, s76
    v_perm_b32 v241, v84, v80, s77
    v_perm_b32 v249, v86, v82, s77
    v_perm_b32 v242, v85, v81, s76
    v_perm_b32 v250, v87, v83, s76
    v_perm_b32 v243, v85, v81, s77
    v_perm_b32 v251, v87, v83, s77
    v_perm_b32 v244, v92, v88, s76
    v_perm_b32 v252, v94, v90, s76
    v_perm_b32 v245, v92, v88, s77
    v_perm_b32 v253, v94, v90, s77
    v_perm_b32 v246, v93, v89, s76
    v_perm_b32 v254, v95, v91, s76
    v_perm_b32 v247, v93, v89, s77
    v_perm_b32 v255, v95, v91, s77
    s_mov_b64 vcc, s[88:89]
    v_cndmask_b32_dpp v82, v240, v248, vcc row_ror:8 row_mask:0xf bank_mask:0xf
    v_cndmask_b32_dpp v86, v241, v249, vcc row_ror:8 row_mask:0xf bank_mask:0xf
    v_cndmask_b32_dpp v90, v242, v250, vcc row_ror:8 row_mask:0xf bank_mask:0xf
    v_cndmask_b32_dpp v94, v243, v251, vcc row_ror:8 row_mask:0xf bank_mask:0xf
    v_cndmask_b32_dpp v83, v244, v252, vcc row_ror:8 row_mask:0xf bank_mask:0xf
    v_cndmask_b32_dpp v87, v245, v253, vcc row_ror:8 row_mask:0xf bank_mask:0xf
    v_cndmask_b32_dpp v91, v246, v254, vcc row_ror:8 row_mask:0xf bank_mask:0xf
    v_cndmask_b32_dpp v95, v247, v255, vcc row_ror:8 row_mask:0xf bank_mask:0xf
    s_not_b64 vcc, s[88:89]
    v_cndmask_b32_dpp v80, v248, v240, vcc row_ror:8 row_mask:0xf bank_mask:0xf
    v_cndmask_b32_dpp v84, v249, v241, vcc row_ror:8 row_mask:0xf bank_mask:0xf
    v_cndmask_b32_dpp v88, v250, v242, vcc row_ror:8 row_mask:0xf bank_mask:0xf
    v_cndmask_b32_dpp v92, v251, v243, vcc row_ror:8 row_mask:0xf bank_mask:0xf
    v_cndmask_b32_dpp v81, v252, v244, vcc row_ror:8 row_mask:0xf bank_mask:0xf
    v_cndmask_b32_dpp v85, v253, v245, vcc row_ror:8 row_mask:0xf bank_mask:0xf
    v_cndmask_b32_dpp v89, v254, v246, vcc row_ror:8 row_mask:0xf bank_mask:0xf
    v_cndmask_b32_dpp v93, v255, v247, vcc row_ror:8 row_mask:0xf bank_mask:0xf
    v_perm_b32 v240, v100, v96, s76
    v_perm_b32 v248, v102, v98, s76
    v_perm_b32 v241, v100, v96, s77
    v_perm_b32 v249, v102, v98, s77
    v_perm_b32 v242, v101, v97, s76
    v_perm_b32 v250, v103, v99, s76
    v_perm_b32 v243, v101, v97, s77
    v_perm_b32 v251, v103, v99, s77
    v_perm_b32 v244, v108, v104, s76
    v_perm_b32 v252, v110, v106, s76
    v_perm_b32 v245, v108, v104, s77
    v_perm_b32 v253, v110, v106, s77
    v_perm_b32 v246, v109, v105, s76
    v_perm_b32 v254, v111, v107, s76
    v_perm_b32 v247, v109, v105, s77
    v_perm_b32 v255, v111, v107, s77
    s_mov_b64 vcc, s[88:89]
    v_cndmask_b32_dpp v98, v240, v248, vcc row_ror:8 row_mask:0xf bank_mask:0xf
    v_cndmask_b32_dpp v102, v241, v249, vcc row_ror:8 row_mask:0xf bank_mask:0xf
    v_cndmask_b32_dpp v106, v242, v250, vcc row_ror:8 row_mask:0xf bank_mask:0xf
    v_cndmask_b32_dpp v110, v243, v251, vcc row_ror:8 row_mask:0xf bank_mask:0xf
    v_cndmask_b32_dpp v99, v244, v252, vcc row_ror:8 row_mask:0xf bank_mask:0xf
    v_cndmask_b32_dpp v103, v245, v253, vcc row_ror:8 row_mask:0xf bank_mask:0xf
    v_cndmask_b32_dpp v107, v246, v254, vcc row_ror:8 row_mask:0xf bank_mask:0xf
    v_cndmask_b32_dpp v111, v247, v255, vcc row_ror:8 row_mask:0xf bank_mask:0xf
    s_not_b64 vcc, s[88:89]
    v_cndmask_b32_dpp v96, v248, v240, vcc row_ror:8 row_mask:0xf bank_mask:0xf
    v_cndmask_b32_dpp v100, v249, v241, vcc row_ror:8 row_mask:0xf bank_mask:0xf
    v_cndmask_b32_dpp v104, v250, v242, vcc row_ror:8 row_mask:0xf bank_mask:0xf
    v_cndmask_b32_dpp v108, v251, v243, vcc row_ror:8 row_mask:0xf bank_mask:0xf
    v_cndmask_b32_dpp v97, v252, v244, vcc row_ror:8 row_mask:0xf bank_mask:0xf
    v_cndmask_b32_dpp v101, v253, v245, vcc row_ror:8 row_mask:0xf bank_mask:0xf
    v_cndmask_b32_dpp v105, v254, v246, vcc row_ror:8 row_mask:0xf bank_mask:0xf
    v_cndmask_b32_dpp v109, v255, v247, vcc row_ror:8 row_mask:0xf bank_mask:0xf
    v_perm_b32 v240, v116, v112, s76
    v_perm_b32 v248, v118, v114, s76
    v_perm_b32 v241, v116, v112, s77
    v_perm_b32 v249, v118, v114, s77
    v_perm_b32 v242, v117, v113, s76
    v_perm_b32 v250, v119, v115, s76
    v_perm_b32 v243, v117, v113, s77
    v_perm_b32 v251, v119, v115, s77
    v_perm_b32 v244, v124, v120, s76
    v_perm_b32 v252, v126, v122, s76
    v_perm_b32 v245, v124, v120, s77
    v_perm_b32 v253, v126, v122, s77
    v_perm_b32 v246, v125, v121, s76
    v_perm_b32 v254, v127, v123, s76
    v_perm_b32 v247, v125, v121, s77
    v_perm_b32 v255, v127, v123, s77
    s_mov_b64 vcc, s[88:89]
    v_cndmask_b32_dpp v114, v240, v248, vcc row_ror:8 row_mask:0xf bank_mask:0xf
    v_cndmask_b32_dpp v118, v241, v249, vcc row_ror:8 row_mask:0xf bank_mask:0xf
    v_cndmask_b32_dpp v122, v242, v250, vcc row_ror:8 row_mask:0xf bank_mask:0xf
    v_cndmask_b32_dpp v126, v243, v251, vcc row_ror:8 row_mask:0xf bank_mask:0xf
    v_cndmask_b32_dpp v115, v244, v252, vcc row_ror:8 row_mask:0xf bank_mask:0xf
    v_cndmask_b32_dpp v119, v245, v253, vcc row_ror:8 row_mask:0xf bank_mask:0xf
    v_cndmask_b32_dpp v123, v246, v254, vcc row_ror:8 row_mask:0xf bank_mask:0xf
    v_cndmask_b32_dpp v127, v247, v255, vcc row_ror:8 row_mask:0xf bank_mask:0xf
    s_not_b64 vcc, s[88:89]
    v_cndmask_b32_dpp v112, v248, v240, vcc row_ror:8 row_mask:0xf bank_mask:0xf
    v_cndmask_b32_dpp v116, v249, v241, vcc row_ror:8 row_mask:0xf bank_mask:0xf
    v_cndmask_b32_dpp v120, v250, v242, vcc row_ror:8 row_mask:0xf bank_mask:0xf
    v_cndmask_b32_dpp v124, v251, v243, vcc row_ror:8 row_mask:0xf bank_mask:0xf
    v_cndmask_b32_dpp v113, v252, v244, vcc row_ror:8 row_mask:0xf bank_mask:0xf
    v_cndmask_b32_dpp v117, v253, v245, vcc row_ror:8 row_mask:0xf bank_mask:0xf
    v_cndmask_b32_dpp v121, v254, v246, vcc row_ror:8 row_mask:0xf bank_mask:0xf
    v_cndmask_b32_dpp v125, v255, v247, vcc row_ror:8 row_mask:0xf bank_mask:0xf
    v_perm_b32 v240, v132, v128, s76
    v_perm_b32 v248, v134, v130, s76
    v_perm_b32 v241, v132, v128, s77
    v_perm_b32 v249, v134, v130, s77
    v_perm_b32 v242, v133, v129, s76
    v_perm_b32 v250, v135, v131, s76
    v_perm_b32 v243, v133, v129, s77
    v_perm_b32 v251, v135, v131, s77
    v_perm_b32 v244, v140, v136, s76
    v_perm_b32 v252, v142, v138, s76
    v_perm_b32 v245, v140, v136, s77
    v_perm_b32 v253, v142, v138, s77
    v_perm_b32 v246, v141, v137, s76
    v_perm_b32 v254, v143, v139, s76
    v_perm_b32 v247, v141, v137, s77
    v_perm_b32 v255, v143, v139, s77
    s_mov_b64 vcc, s[88:89]
    v_cndmask_b32_dpp v130, v240, v248, vcc row_ror:8 row_mask:0xf bank_mask:0xf
    v_cndmask_b32_dpp v134, v241, v249, vcc row_ror:8 row_mask:0xf bank_mask:0xf
    v_cndmask_b32_dpp v138, v242, v250, vcc row_ror:8 row_mask:0xf bank_mask:0xf
    v_cndmask_b32_dpp v142, v243, v251, vcc row_ror:8 row_mask:0xf bank_mask:0xf
    v_cndmask_b32_dpp v131, v244, v252, vcc row_ror:8 row_mask:0xf bank_mask:0xf
    v_cndmask_b32_dpp v135, v245, v253, vcc row_ror:8 row_mask:0xf bank_mask:0xf
    v_cndmask_b32_dpp v139, v246, v254, vcc row_ror:8 row_mask:0xf bank_mask:0xf
    v_cndmask_b32_dpp v143, v247, v255, vcc row_ror:8 row_mask:0xf bank_mask:0xf
    s_not_b64 vcc, s[88:89]
    v_cndmask_b32_dpp v128, v248, v240, vcc row_ror:8 row_mask:0xf bank_mask:0xf
    v_cndmask_b32_dpp v132, v249, v241, vcc row_ror:8 row_mask:0xf bank_mask:0xf
    v_cndmask_b32_dpp v136, v250, v242, vcc row_ror:8 row_mask:0xf bank_mask:0xf
    v_cndmask_b32_dpp v140, v251, v243, vcc row_ror:8 row_mask:0xf bank_mask:0xf
    v_cndmask_b32_dpp v129, v252, v244, vcc row_ror:8 row_mask:0xf bank_mask:0xf
    v_cndmask_b32_dpp v133, v253, v245, vcc row_ror:8 row_mask:0xf bank_mask:0xf
    v_cndmask_b32_dpp v137, v254, v246, vcc row_ror:8 row_mask:0xf bank_mask:0xf
    v_cndmask_b32_dpp v141, v255, v247, vcc row_ror:8 row_mask:0xf bank_mask:0xf
    s_waitcnt vmcnt(7)
    v_mfma_f32_16x16x32_bf16 v[160:163], v[144:147], v[32:35], 0
    v_mfma_f32_16x16x32_bf16 v[164:167], v[144:147], v[36:39], 0
    v_mfma_f32_16x16x32_bf16 v[168:171], v[144:147], v[40:43], 0
    v_mfma_f32_16x16x32_bf16 v[172:175], v[144:147], v[44:47], 0
    s_add_u32 s96, s59, 58368
    buffer_load_dwordx4 v[144:147], v16, s[36:39], s96 offen sc1
    s_waitcnt vmcnt(7)
    v_mfma_f32_16x16x32_bf16 v[160:163], v[148:151], v[48:51], v[160:163]
    v_mfma_f32_16x16x32_bf16 v[164:167], v[148:151], v[52:55], v[164:167]
    v_mfma_f32_16x16x32_bf16 v[168:171], v[148:151], v[56:59], v[168:171]
    v_mfma_f32_16x16x32_bf16 v[172:175], v[148:151], v[60:63], v[172:175]
    s_add_u32 s96, s59, 59392
    buffer_load_dwordx4 v[148:151], v16, s[36:39], s96 offen sc1
    s_waitcnt vmcnt(7)
    v_mfma_f32_16x16x32_bf16 v[160:163], v[152:155], v[64:67], v[160:163]
    v_mfma_f32_16x16x32_bf16 v[164:167], v[152:155], v[68:71], v[164:167]
    v_mfma_f32_16x16x32_bf16 v[168:171], v[152:155], v[72:75], v[168:171]
    v_mfma_f32_16x16x32_bf16 v[172:175], v[152:155], v[76:79], v[172:175]
    s_add_u32 s96, s59, 60416
    buffer_load_dwordx4 v[152:155], v16, s[36:39], s96 offen sc1
    s_waitcnt vmcnt(7)
    v_mfma_f32_16x16x32_bf16 v[160:163], v[156:159], v[80:83], v[160:163]
    v_mfma_f32_16x16x32_bf16 v[164:167], v[156:159], v[84:87], v[164:167]
    v_mfma_f32_16x16x32_bf16 v[168:171], v[156:159], v[88:91], v[168:171]
    v_mfma_f32_16x16x32_bf16 v[172:175], v[156:159], v[92:95], v[172:175]
    s_add_u32 s96, s59, 61440
    buffer_load_dwordx4 v[156:159], v16, s[36:39], s96 offen sc1
    s_waitcnt vmcnt(7)
    v_mfma_f32_16x16x32_bf16 v[160:163], v[224:227], v[96:99], v[160:163]
    v_mfma_f32_16x16x32_bf16 v[164:167], v[224:227], v[100:103], v[164:167]
    v_mfma_f32_16x16x32_bf16 v[168:171], v[224:227], v[104:107], v[168:171]
    v_mfma_f32_16x16x32_bf16 v[172:175], v[224:227], v[108:111], v[172:175]
    s_add_u32 s96, s59, 62464
    buffer_load_dwordx4 v[224:227], v16, s[36:39], s96 offen sc1
    s_add_u32 s65, s65, 512
    s_mov_b64 exec, 0xf
    buffer_load_dword v24, v5, s[36:39], s65 offen sc1
    s_mov_b64 exec, -1
    s_waitcnt vmcnt(8)
    s_nop 4
    v_mfma_f32_16x16x32_bf16 v[160:163], v[228:231], v[112:115], v[160:163]
    v_mfma_f32_16x16x32_bf16 v[164:167], v[228:231], v[116:119], v[164:167]
    v_mfma_f32_16x16x32_bf16 v[168:171], v[228:231], v[120:123], v[168:171]
    v_mfma_f32_16x16x32_bf16 v[172:175], v[228:231], v[124:127], v[172:175]
    s_add_u32 s96, s59, 63488
    buffer_load_dwordx4 v[228:231], v16, s[36:39], s96 offen sc1
    s_waitcnt vmcnt(8)
    v_mfma_f32_16x16x32_bf16 v[160:163], v[232:235], v[128:131], v[160:163]
    v_mfma_f32_16x16x32_bf16 v[164:167], v[232:235], v[132:135], v[164:167]
    v_mfma_f32_16x16x32_bf16 v[168:171], v[232:235], v[136:139], v[168:171]
    v_mfma_f32_16x16x32_bf16 v[172:175], v[232:235], v[140:143], v[172:175]
    s_waitcnt vmcnt(7)
    v_mfma_f32_16x16x32_bf16 v[176:179], v[236:239], v[32:35], 0
    v_mfma_f32_16x16x32_bf16 v[180:183], v[236:239], v[36:39], 0
    v_mfma_f32_16x16x32_bf16 v[184:187], v[236:239], v[40:43], 0
    v_mfma_f32_16x16x32_bf16 v[188:191], v[236:239], v[44:47], 0
    s_waitcnt vmcnt(1)
    v_cmp_ne_u32 s[90:91], s53, v24
    s_nop 0
    s_and_b32 s90, s90, 0xf
    s_cbranch_scc0 L_fbok_39
    s_mov_b32 exec_lo, 0xf
    s_mov_b32 exec_hi, 0x0
    s_mov_b32 s78, 0
L_poll_40:
    buffer_load_dword v4, v5, s[36:39], s65 offen sc1
    s_add_u32 s78, s78, 1
    s_cmp_ge_u32 s78, 200000
    s_cbranch_scc1 L_pollend_41
    s_waitcnt vmcnt(0)
    v_cmp_ne_u32 vcc, s53, v4
    s_nop 1
    s_cbranch_vccz L_pollend_41
    s_sleep 2
    s_branch L_poll_40
L_pollend_41:
    s_waitcnt vmcnt(0)
    s_mov_b64 exec, -1
L_fbok_39:
    s_add_u32 s96, s59, 458752
    buffer_load_dwordx4 v[232:235], v16, s[36:39], s96 offen sc1
    s_add_u32 s96, s59, 459776
    buffer_load_dwordx4 v[236:239], v16, s[36:39], s96 offen sc1
    s_add_u32 m0, s58, 149632
    s_nop 0
    buffer_load_dwordx4 v16, s[36:39], s57 offen sc1 lds
L_cnt_42:
    ds_read_b32 v26, v25
    s_waitcnt lgkmcnt(0)
    v_readfirstlane_b32 s90, v26
    s_nop 0
    s_cmp_lt_u32 s90, 8
    s_cbranch_scc1 L_cnt_42
    s_waitcnt vmcnt(9)
    v_mfma_f32_16x16x32_bf16 v[176:179], v[144:147], v[48:51], v[176:179]
    v_mfma_f32_16x16x32_bf16 v[180:183], v[144:147], v[52:55], v[180:183]
    ds_write_b64 v18, v[160:161] offset:0
    v_mfma_f32_16x16x32_bf16 v[184:187], v[144:147], v[56:59], v[184:187]
    v_mfma_f32_16x16x32_bf16 v[188:191], v[144:147], v[60:63], v[188:191]
    ds_write_b64 v18, v[162:163] offset:16384
    s_add_u32 s96, s59, 460800
    buffer_load_dwordx4 v[144:147], v16, s[36:39], s96 offen sc1
    s_waitcnt vmcnt(9)
    v_mfma_f32_16x16x32_bf16 v[176:179], v[148:151], v[64:67], v[176:179]
    v_mfma_f32_16x16x32_bf16 v[180:183], v[148:151], v[68:71], v[180:183]
    ds_write_b64 v18, v[164:165] offset:512
    v_mfma_f32_16x16x32_bf16 v[184:187], v[148:151], v[72:75], v[184:187]
    v_mfma_f32_16x16x32_bf16 v[188:191], v[148:151], v[76:79], v[188:191]
    ds_write_b64 v18, v[166:167] offset:16896
    s_add_u32 s96, s59, 461824
    buffer_load_dwordx4 v[148:151], v16, s[36:39], s96 offen sc1
    s_waitcnt vmcnt(9)
    v_mfma_f32_16x16x32_bf16 v[176:179], v[152:155], v[80:83], v[176:179]
    v_mfma_f32_16x16x32_bf16 v[180:183], v[152:155], v[84:87], v[180:183]
    ds_write_b64 v18, v[168:169] offset:1024
    v_mfma_f32_16x16x32_bf16 v[184:187], v[152:155], v[88:91], v[184:187]
    v_mfma_f32_16x16x32_bf16 v[188:191], v[152:155], v[92:95], v[188:191]
    ds_write_b64 v18, v[170:171] offset:17408
    s_add_u32 s96, s59, 462848
    buffer_load_dwordx4 v[152:155], v16, s[36:39], s96 offen sc1
    s_waitcnt vmcnt(9)
    v_mfma_f32_16x16x32_bf16 v[176:179], v[156:159], v[96:99], v[176:179]
    v_mfma_f32_16x16x32_bf16 v[180:183], v[156:159], v[100:103], v[180:183]
    ds_write_b64 v18, v[172:173] offset:1536
    v_mfma_f32_16x16x32_bf16 v[184:187], v[156:159], v[104:107], v[184:187]
    v_mfma_f32_16x16x32_bf16 v[188:191], v[156:159], v[108:111], v[188:191]
    ds_write_b64 v18, v[174:175] offset:17920
    s_add_u32 s96, s59, 463872
    buffer_load_dwordx4 v[156:159], v16, s[36:39], s96 offen sc1
    s_waitcnt vmcnt(9)
    v_mfma_f32_16x16x32_bf16 v[176:179], v[224:227], v[112:115], v[176:179]
    v_mfma_f32_16x16x32_bf16 v[180:183], v[224:227], v[116:119], v[180:183]
    v_mfma_f32_16x16x32_bf16 v[184:187], v[224:227], v[120:123], v[184:187]
    v_mfma_f32_16x16x32_bf16 v[188:191], v[224:227], v[124:127], v[188:191]
    s_add_u32 s96, s59, 464896
    buffer_load_dwordx4 v[224:227], v16, s[36:39], s96 offen sc1
    s_waitcnt vmcnt(8)
    v_mfma_f32_16x16x32_bf16 v[176:179], v[228:231], v[128:131], v[176:179]
    v_mfma_f32_16x16x32_bf16 v[180:183], v[228:231], v[132:135], v[180:183]
    v_mfma_f32_16x16x32_bf16 v[184:187], v[228:231], v[136:139], v[184:187]
    v_mfma_f32_16x16x32_bf16 v[188:191], v[228:231], v[140:143], v[188:191]
    s_add_u32 s96, s59, 516096
    buffer_load_dwordx4 v[228:231], v16, s[36:39], s96 offen sc1
    s_waitcnt vmcnt(8)
    v_mfma_f32_16x16x32_bf16 v[192:195], v[232:235], v[32:35], 0
    v_mfma_f32_16x16x32_bf16 v[196:199], v[232:235], v[36:39], 0
    v_mfma_f32_16x16x32_bf16 v[200:203], v[232:235], v[40:43], 0
    v_mfma_f32_16x16x32_bf16 v[204:207], v[232:235], v[44:47], 0
    s_add_u32 s96, s59, 517120
    buffer_load_dwordx4 v[232:235], v16, s[36:39], s96 offen sc1
    s_waitcnt vmcnt(8)
    v_mfma_f32_16x16x32_bf16 v[192:195], v[236:239], v[48:51], v[192:195]
    v_mfma_f32_16x16x32_bf16 v[196:199], v[236:239], v[52:55], v[196:199]
    v_mfma_f32_16x16x32_bf16 v[200:203], v[236:239], v[56:59], v[200:203]
    v_mfma_f32_16x16x32_bf16 v[204:207], v[236:239], v[60:63], v[204:207]
    s_add_u32 s96, s59, 518144
    buffer_load_dwordx4 v[236:239], v16, s[36:39], s96 offen sc1
    s_waitcnt vmcnt(7)
    v_mfma_f32_16x16x32_bf16 v[192:195], v[144:147], v[64:67], v[192:195]
    v_mfma_f32_16x16x32_bf16 v[196:199], v[144:147], v[68:71], v[196:199]
    ds_write_b64 v18, v[176:177] offset:32768
    v_mfma_f32_16x16x32_bf16 v[200:203], v[144:147], v[72:75], v[200:203]
    v_mfma_f32_16x16x32_bf16 v[204:207], v[144:147], v[76:79], v[204:207]
    ds_write_b64 v18, v[178:179] offset:49152
    s_add_u32 s96, s59, 519168
    buffer_load_dwordx4 v[144:147], v16, s[36:39], s96 offen sc1
    s_waitcnt vmcnt(7)
    v_mfma_f32_16x16x32_bf16 v[192:195], v[148:151], v[80:83], v[192:195]
    v_mfma_f32_16x16x32_bf16 v[196:199], v[148:151], v[84:87], v[196:199]
    ds_write_b64 v18, v[180:181] offset:33280
    v_mfma_f32_16x16x32_bf16 v[200:203], v[148:151], v[88:91], v[200:203]
    v_mfma_f32_16x16x32_bf16 v[204:207], v[148:151], v[92:95], v[204:207]
    ds_write_b64 v18, v[182:183] offset:49664
    s_add_u32 s96, s59, 520192
    buffer_load_dwordx4 v[148:151], v16, s[36:39], s96 offen sc1
    s_waitcnt vmcnt(7)
    v_mfma_f32_16x16x32_bf16 v[192:195], v[152:155], v[96:99], v[192:195]
    v_mfma_f32_16x16x32_bf16 v[196:199], v[152:155], v[100:103], v[196:199]
    ds_write_b64 v18, v[184:185] offset:33792
    v_mfma_f32_16x16x32_bf16 v[200:203], v[152:155], v[104:107], v[200:203]
    v_mfma_f32_16x16x32_bf16 v[204:207], v[152:155], v[108:111], v[204:207]
    ds_write_b64 v18, v[186:187] offset:50176
    s_add_u32 s96, s59, 521216
    buffer_load_dwordx4 v[152:155], v16, s[36:39], s96 offen sc1
    s_waitcnt vmcnt(7)
    v_mfma_f32_16x16x32_bf16 v[192:195], v[156:159], v[112:115], v[192:195]
    v_mfma_f32_16x16x32_bf16 v[196:199], v[156:159], v[116:119], v[196:199]
    ds_write_b64 v18, v[188:189] offset:34304
    v_mfma_f32_16x16x32_bf16 v[200:203], v[156:159], v[120:123], v[200:203]
    v_mfma_f32_16x16x32_bf16 v[204:207], v[156:159], v[124:127], v[204:207]
    ds_write_b64 v18, v[190:191] offset:50688
    s_add_u32 s96, s59, 522240
    buffer_load_dwordx4 v[156:159], v16, s[36:39], s96 offen sc1
    s_waitcnt vmcnt(7)
    v_mfma_f32_16x16x32_bf16 v[192:195], v[224:227], v[128:131], v[192:195]
    v_mfma_f32_16x16x32_bf16 v[196:199], v[224:227], v[132:135], v[196:199]
    v_mfma_f32_16x16x32_bf16 v[200:203], v[224:227], v[136:139], v[200:203]
    v_mfma_f32_16x16x32_bf16 v[204:207], v[224:227], v[140:143], v[204:207]
    s_waitcnt vmcnt(6)
    v_mfma_f32_16x16x32_bf16 v[208:211], v[228:231], v[32:35], 0
    v_mfma_f32_16x16x32_bf16 v[212:215], v[228:231], v[36:39], 0
    v_mfma_f32_16x16x32_bf16 v[216:219], v[228:231], v[40:43], 0
    v_mfma_f32_16x16x32_bf16 v[220:223], v[228:231], v[44:47], 0
    s_waitcnt vmcnt(5)
    v_mfma_f32_16x16x32_bf16 v[208:211], v[232:235], v[48:51], v[208:211]
    v_mfma_f32_16x16x32_bf16 v[212:215], v[232:235], v[52:55], v[212:215]
    v_mfma_f32_16x16x32_bf16 v[216:219], v[232:235], v[56:59], v[216:219]
    v_mfma_f32_16x16x32_bf16 v[220:223], v[232:235], v[60:63], v[220:223]
    s_waitcnt vmcnt(4)
    v_mfma_f32_16x16x32_bf16 v[208:211], v[236:239], v[64:67], v[208:211]
    v_mfma_f32_16x16x32_bf16 v[212:215], v[236:239], v[68:71], v[212:215]
    ds_write_b64 v19, v[192:193] offset:0
    v_mfma_f32_16x16x32_bf16 v[216:219], v[236:239], v[72:75], v[216:219]
    v_mfma_f32_16x16x32_bf16 v[220:223], v[236:239], v[76:79], v[220:223]
    ds_write_b64 v19, v[194:195] offset:16384
    s_waitcnt vmcnt(3)
    v_mfma_f32_16x16x32_bf16 v[208:211], v[144:147], v[80:83], v[208:211]
    v_mfma_f32_16x16x32_bf16 v[212:215], v[144:147], v[84:87], v[212:215]
    ds_write_b64 v19, v[196:197] offset:512
    v_mfma_f32_16x16x32_bf16 v[216:219], v[144:147], v[88:91], v[216:219]
    v_mfma_f32_16x16x32_bf16 v[220:223], v[144:147], v[92:95], v[220:223]
    ds_write_b64 v19, v[198:199] offset:16896
    s_waitcnt vmcnt(2)
    v_mfma_f32_16x16x32_bf16 v[208:211], v[148:151], v[96:99], v[208:211]
    v_mfma_f32_16x16x32_bf16 v[212:215], v[148:151], v[100:103], v[212:215]
    ds_write_b64 v19, v[200:201] offset:1024
    v_mfma_f32_16x16x32_bf16 v[216:219], v[148:151], v[104:107], v[216:219]
    v_mfma_f32_16x16x32_bf16 v[220:223], v[148:151], v[108:111], v[220:223]
    ds_write_b64 v19, v[202:203] offset:17408
    s_waitcnt vmcnt(1)
    v_mfma_f32_16x16x32_bf16 v[208:211], v[152:155], v[112:115], v[208:211]
    v_mfma_f32_16x16x32_bf16 v[212:215], v[152:155], v[116:119], v[212:215]
    ds_write_b64 v19, v[204:205] offset:1536
    v_mfma_f32_16x16x32_bf16 v[216:219], v[152:155], v[120:123], v[216:219]
    v_mfma_f32_16x16x32_bf16 v[220:223], v[152:155], v[124:127], v[220:223]
    ds_write_b64 v19, v[206:207] offset:17920
    s_waitcnt vmcnt(0)
    v_mfma_f32_16x16x32_bf16 v[208:211], v[156:159], v[128:131], v[208:211]
    v_mfma_f32_16x16x32_bf16 v[212:215], v[156:159], v[132:135], v[212:215]
    v_mfma_f32_16x16x32_bf16 v[216:219], v[156:159], v[136:139], v[216:219]
    v_mfma_f32_16x16x32_bf16 v[220:223], v[156:159], v[140:143], v[220:223]
    s_nop 4
    ds_write_b64 v19, v[208:209] offset:32768
    ds_write_b64 v19, v[210:211] offset:49152
    ds_write_b64 v19, v[212:213] offset:33280
    ds_write_b64 v19, v[214:215] offset:49664
    ds_write_b64 v19, v[216:217] offset:33792
    ds_write_b64 v19, v[218:219] offset:50176
    ds_write_b64 v19, v[220:221] offset:34304
    ds_write_b64 v19, v[222:223] offset:50688
    s_waitcnt lgkmcnt(0)
    s_barrier
    ds_read_b64 v[28:29], v17
    ds_read_b64 v[30:31], v17 offset:16
    ds_read_b64 v[64:65], v20 offset:0
    ds_read_b64 v[66:67], v20 offset:512
    ds_read_b64 v[68:69], v20 offset:1024
    ds_read_b64 v[70:71], v20 offset:1536
    ds_read_b64 v[72:73], v20 offset:2048
    ds_read_b64 v[74:75], v20 offset:2560
    ds_read_b64 v[76:77], v20 offset:3072
    ds_read_b64 v[78:79], v20 offset:3584
    ds_read_b64 v[80:81], v20 offset:4096
    ds_read_b64 v[82:83], v20 offset:4608
    ds_read_b64 v[84:85], v20 offset:5120
    ds_read_b64 v[86:87], v20 offset:5632
    s_waitcnt lgkmcnt(12)
    v_lshlrev_b32 v8, 16, v28
    v_and_b32 v10, 0xffff0000, v28
    v_lshlrev_b32 v12, 16, v29
    v_and_b32 v14, 0xffff0000, v29
    v_lshlrev_b32 v9, 16, v30
    v_and_b32 v11, 0xffff0000, v30
    v_lshlrev_b32 v13, 16, v31
    v_and_b32 v15, 0xffff0000, v31
    ds_read_b64 v[88:89], v20 offset:6144
    ds_read_b64 v[90:91], v20 offset:6656
    ds_read_b64 v[92:93], v20 offset:7168
    ds_read_b64 v[94:95], v20 offset:7680
    ds_read_b64 v[96:97], v20 offset:8192
    ds_read_b64 v[98:99], v20 offset:8704
    ds_read_b64 v[100:101], v20 offset:9216
    ds_read_b64 v[102:103], v20 offset:9728
    ds_read_b64 v[104:105], v20 offset:10240
    ds_read_b64 v[106:107], v20 offset:10752
    ds_read_b64 v[108:109], v20 offset:11264
    ds_read_b64 v[110:111], v20 offset:11776
    ds_read_b64 v[112:113], v20 offset:12288
    ds_read_b64 v[114:115], v20 offset:12800
    ds_read_b64 v[116:117], v20 offset:13312
    ds_read_b64 v[118:119], v20 offset:13824
    ds_read_b64 v[120:121], v20 offset:14336
    ds_read_b64 v[122:123], v20 offset:14848
    ds_read_b64 v[124:125], v20 offset:15360
    ds_read_b64 v[126:127], v20 offset:15872
    s_waitcnt lgkmcnt(15)
    v_add_f32 v8, v8, v64
    v_add_f32 v9, v9, v65
    v_add_f32 v10, v10, v66
    v_add_f32 v11, v11, v67
    v_add_f32 v12, v12, v68
    v_add_f32 v13, v13, v69
    v_add_f32 v14, v14, v70
    v_add_f32 v15, v15, v71
    s_waitcnt lgkmcnt(15)
    v_add_f32 v8, v8, v72
    v_add_f32 v9, v9, v73
    v_add_f32 v10, v10, v74
    v_add_f32 v11, v11, v75
    v_add_f32 v12, v12, v76
    v_add_f32 v13, v13, v77
    v_add_f32 v14, v14, v78
    v_add_f32 v15, v15, v79
    s_waitcnt lgkmcnt(15)
    v_add_f32 v8, v8, v80
    v_add_f32 v9, v9, v81
    v_add_f32 v10, v10, v82
    v_add_f32 v11, v11, v83
    v_add_f32 v12, v12, v84
    v_add_f32 v13, v13, v85
    v_add_f32 v14, v14, v86
    v_add_f32 v15, v15, v87
    s_waitcnt lgkmcnt(15)
    v_add_f32 v8, v8, v88
    v_add_f32 v9, v9, v89
    v_add_f32 v10, v10, v90
    v_add_f32 v11, v11, v91
    v_add_f32 v12, v12, v92
    v_add_f32 v13, v13, v93
    v_add_f32 v14, v14, v94
    v_add_f32 v15, v15, v95
    s_waitcnt lgkmcnt(12)
    v_add_f32 v8, v8, v96
    v_add_f32 v9, v9, v97
    v_add_f32 v10, v10, v98
    v_add_f32 v11, v11, v99
    v_add_f32 v12, v12, v100
    v_add_f32 v13, v13, v101
    v_add_f32 v14, v14, v102
    v_add_f32 v15, v15, v103
    s_waitcnt lgkmcnt(8)
    v_add_f32 v8, v8, v104
    v_add_f32 v9, v9, v105
    v_add_f32 v10, v10, v106
    v_add_f32 v11, v11, v107
    v_add_f32 v12, v12, v108
    v_add_f32 v13, v13, v109
    v_add_f32 v14, v14, v110
    v_add_f32 v15, v15, v111
    s_waitcnt lgkmcnt(4)
    v_add_f32 v8, v8, v112
    v_add_f32 v9, v9, v113
    v_add_f32 v10, v10, v114
    v_add_f32 v11, v11, v115
    v_add_f32 v12, v12, v116
    v_add_f32 v13, v13, v117
    v_add_f32 v14, v14, v118
    v_add_f32 v15, v15, v119
    s_waitcnt lgkmcnt(0)
    v_add_f32 v8, v8, v120
    v_add_f32 v9, v9, v121
    v_add_f32 v10, v10, v122
    v_add_f32 v11, v11, v123
    v_add_f32 v12, v12, v124
    v_add_f32 v13, v13, v125
    v_add_f32 v14, v14, v126
    v_add_f32 v15, v15, v127
    v_cvt_pk_bf16_f32 v44, v8, v10
    v_cvt_pk_bf16_f32 v45, v12, v14
    buffer_store_dwordx2 v[44:45], v21, s[32:35], s63 offen offset:0 nt
    v_cvt_pk_bf16_f32 v46, v9, v11
    v_cvt_pk_bf16_f32 v47, v13, v15
    buffer_store_dwordx2 v[46:47], v21, s[32:35], s63 offen offset:896 nt
    s_or_b32 s60, s6, s4
    s_cmp_lg_u32 s60, 0
    s_cbranch_scc1 L_noepoch_43
    s_add_u32 s60, s55, 1
    v_mov_b32 v4, s60
    v_mov_b32 v5, 0
    s_mov_b64 exec, 1
    buffer_store_dword v4, v5, s[36:39], s54 offen sc1
L_noepoch_43:
L_fin:
L_end:
    s_endpgm
L_rolec:
    s_lshr_b32 s96, s98, 3
    s_lshl_b32 s97, s5, 4
    s_add_u32 s96, s96, s97
    s_mul_i32 s96, s96, 57344
    s_and_b32 s97, s98, 7
    s_lshl_b32 s97, s97, 11
    s_add_u32 s96, s96, s97
    s_add_u32 s96, s96, 2097152
    v_add_u32 v4, s96, v15
    s_lshl_b32 s97, s5, 7
    s_add_u32 s97, s97, s98
    s_mul_i32 s96, s97, 1792
    s_sub_u32 s96, s96, 2048
    v_add_u32 v5, s96, v15
    v_cmp_le_u32 vcc, 16, v1
    s_mul_i32 s96, s97, 224
    s_add_u32 s96, s96, 1831168
    v_cndmask_b32 v4, v4, v5, vcc
    v_add_u32 v5, s96, v15
    v_cmp_le_u32 vcc, 30, v1
    s_and_b32 s96, s98, 31
    s_lshl_b32 s96, s96, 7
    s_add_u32 s96, s96, s54
    s_add_u32 s96, s96, 1024
    v_cndmask_b32 v4, v4, v5, vcc
    v_mov_b32 v5, s96
    v_cmp_le_u32 vcc, 32, v1
    s_nop 1
    v_cndmask_b32 v4, v4, v5, vcc
    s_mov_b32 exec_lo, 0xffff0000
    s_mov_b32 exec_hi, 1
    buffer_load_dword v31, v4, s[36:39], 0 offen sc1
    s_mov_b64 exec, -1
    s_lshl_b32 s96, s5, 4
    s_add_u32 s96, s96, s98
    s_sub_u32 s96, s96, 112
    s_mul_i32 s96, s96, 12544
    s_bfm_b64 exec, 49, 0
    buffer_load_dword v31, v15, s[28:31], s96 offen
    s_add_u32 s96, s96, 6272
    buffer_load_dword v31, v15, s[28:31], s96 offen
    s_mov_b64 exec, -1
    s_add_u32 s98, s98, 16
    s_sub_u32 s98, s98, 128
    v_mul_u32_u24 v4, 4682, v1
    v_lshrrev_b32 v4, 16, v4
    v_mul_u32_u24 v4, 1792, v4
    v_add_u32 v4, v4, v15
    s_mul_i32 s96, s5, 16
    s_add_u32 s96, s96, s98
    s_and_b32 s96, s96, 127
    s_mul_i32 s96, s96, 14336
    s_bfm_b64 exec, 56, 0
    buffer_load_dword v31, v4, s[24:27], s96 offen
    s_mov_b64 exec, -1
    s_add_u32 s98, s98, 16
    v_mul_u32_u24 v4, 4682, v1
    v_lshrrev_b32 v4, 16, v4
    v_mul_u32_u24 v4, 1792, v4
    v_add_u32 v4, v4, v15
    s_mul_i32 s96, s5, 16
    s_add_u32 s96, s96, s98
    s_and_b32 s96, s96, 127
    s_mul_i32 s96, s96, 14336
    s_bfm_b64 exec, 56, 0
    buffer_load_dword v31, v4, s[24:27], s96 offen
    s_mov_b64 exec, -1
    s_add_u32 s98, s98, 16
    v_mul_u32_u24 v4, 4682, v1
    v_lshrrev_b32 v4, 16, v4
    v_mul_u32_u24 v4, 1792, v4
    v_add_u32 v4, v4, v15
    s_mul_i32 s96, s5, 16
    s_add_u32 s96, s96, s98
    s_and_b32 s96, s96, 127
    s_mul_i32 s96, s96, 14336
    s_bfm_b64 exec, 56, 0
    buffer_load_dword v31, v4, s[24:27], s96 offen
    s_mov_b64 exec, -1
    s_add_u32 s98, s98, 16
    v_mul_u32_u24 v4, 4682, v1
    v_lshrrev_b32 v4, 16, v4
    v_mul_u32_u24 v4, 1792, v4
    v_add_u32 v4, v4, v15
    s_mul_i32 s96, s5, 16
    s_add_u32 s96, s96, s98
    s_and_b32 s96, s96, 127
    s_mul_i32 s96, s96, 14336
    s_bfm_b64 exec, 56, 0
    buffer_load_dword v31, v4, s[24:27], s96 offen
    s_mov_b64 exec, -1
    s_add_u32 s98, s98, 16
    v_mul_u32_u24 v4, 4682, v1
    v_lshrrev_b32 v4, 16, v4
    v_mul_u32_u24 v4, 1792, v4
    v_add_u32 v4, v4, v15
    s_mul_i32 s96, s5, 16
    s_add_u32 s96, s96, s98
    s_and_b32 s96, s96, 127
    s_mul_i32 s96, s96, 14336
    s_bfm_b64 exec, 56, 0
    buffer_load_dword v31, v4, s[24:27], s96 offen
    s_mov_b64 exec, -1
    s_add_u32 s98, s98, 16
    v_mul_u32_u24 v4, 4682, v1
    v_lshrrev_b32 v4, 16, v4
    v_mul_u32_u24 v4, 1792, v4
    v_add_u32 v4, v4, v15
    s_mul_i32 s96, s5, 16
    s_add_u32 s96, s96, s98
    s_and_b32 s96, s96, 127
    s_mul_i32 s96, s96, 14336
    s_bfm_b64 exec, 56, 0
    buffer_load_dword v31, v4, s[24:27], s96 offen
    s_mov_b64 exec, -1
    s_add_u32 s98, s98, 16
    v_mul_u32_u24 v4, 4682, v1
    v_lshrrev_b32 v4, 16, v4
    v_mul_u32_u24 v4, 1792, v4
    v_add_u32 v4, v4, v15
    s_mul_i32 s96, s5, 16
    s_add_u32 s96, s96, s98
    s_and_b32 s96, s96, 127
    s_mul_i32 s96, s96, 14336
    s_bfm_b64 exec, 56, 0
    buffer_load_dword v31, v4, s[24:27], s96 offen
    s_mov_b64 exec, -1
    s_add_u32 s98, s98, 16
    v_mul_u32_u24 v4, 4682, v1
    v_lshrrev_b32 v4, 16, v4
    v_mul_u32_u24 v4, 1792, v4
    v_add_u32 v4, v4, v15
    s_mul_i32 s96, s5, 16
    s_add_u32 s96, s96, s98
    s_and_b32 s96, s96, 127
    s_mul_i32 s96, s96, 14336
    s_bfm_b64 exec, 56, 0
    buffer_load_dword v31, v4, s[24:27], s96 offen
    s_mov_b64 exec, -1
    s_add_u32 s98, s98, 16
    s_sub_u32 s98, s98, 128
    v_mul_u32_u24 v4, 4682, v1
    v_lshrrev_b32 v4, 16, v4
    v_mul_u32_u24 v4, 1792, v4
    v_add_u32 v4, v4, v15
    s_mul_i32 s96, s5, 16
    s_add_u32 s96, s96, s98
    s_and_b32 s96, s96, 127
    s_mul_i32 s96, s96, 14336
    s_bfm_b64 exec, 56, 0
    buffer_load_dword v31, v4, s[20:23], s96 offen
    s_mov_b64 exec, -1
    s_add_u32 s98, s98, 16
    v_mul_u32_u24 v4, 4682, v1
    v_lshrrev_b32 v4, 16, v4
    v_mul_u32_u24 v4, 1792, v4
    v_add_u32 v4, v4, v15
    s_mul_i32 s96, s5, 16
    s_add_u32 s96, s96, s98
    s_and_b32 s96, s96, 127
    s_mul_i32 s96, s96, 14336
    s_bfm_b64 exec, 56, 0
    buffer_load_dword v31, v4, s[20:23], s96 offen
    s_mov_b64 exec, -1
    s_add_u32 s98, s98, 16
    v_mul_u32_u24 v4, 4682, v1
    v_lshrrev_b32 v4, 16, v4
    v_mul_u32_u24 v4, 1792, v4
    v_add_u32 v4, v4, v15
    s_mul_i32 s96, s5, 16
    s_add_u32 s96, s96, s98
    s_and_b32 s96, s96, 127
    s_mul_i32 s96, s96, 14336
    s_bfm_b64 exec, 56, 0
    buffer_load_dword v31, v4, s[20:23], s96 offen
    s_mov_b64 exec, -1
    s_add_u32 s98, s98, 16
    v_mul_u32_u24 v4, 4682, v1
    v_lshrrev_b32 v4, 16, v4
    v_mul_u32_u24 v4, 1792, v4
    v_add_u32 v4, v4, v15
    s_mul_i32 s96, s5, 16
    s_add_u32 s96, s96, s98
    s_and_b32 s96, s96, 127
    s_mul_i32 s96, s96, 14336
    s_bfm_b64 exec, 56, 0
    buffer_load_dword v31, v4, s[20:23], s96 offen
    s_mov_b64 exec, -1
    s_add_u32 s98, s98, 16
    v_mul_u32_u24 v4, 4682, v1
    v_lshrrev_b32 v4, 16, v4
    v_mul_u32_u24 v4, 1792, v4
    v_add_u32 v4, v4, v15
    s_mul_i32 s96, s5, 16
    s_add_u32 s96, s96, s98
    s_and_b32 s96, s96, 127
    s_mul_i32 s96, s96, 14336
    s_bfm_b64 exec, 56, 0
    buffer_load_dword v31, v4, s[20:23], s96 offen
    s_mov_b64 exec, -1
    s_add_u32 s98, s98, 16
    v_mul_u32_u24 v4, 4682, v1
    v_lshrrev_b32 v4, 16, v4
    v_mul_u32_u24 v4, 1792, v4
    v_add_u32 v4, v4, v15
    s_mul_i32 s96, s5, 16
    s_add_u32 s96, s96, s98
    s_and_b32 s96, s96, 127
    s_mul_i32 s96, s96, 14336
    s_bfm_b64 exec, 56, 0
    buffer_load_dword v31, v4, s[20:23], s96 offen
    s_mov_b64 exec, -1
    s_add_u32 s98, s98, 16
    v_mul_u32_u24 v4, 4682, v1
    v_lshrrev_b32 v4, 16, v4
    v_mul_u32_u24 v4, 1792, v4
    v_add_u32 v4, v4, v15
    s_mul_i32 s96, s5, 16
    s_add_u32 s96, s96, s98
    s_and_b32 s96, s96, 127
    s_mul_i32 s96, s96, 14336
    s_bfm_b64 exec, 56, 0
    buffer_load_dword v31, v4, s[20:23], s96 offen
    s_mov_b64 exec, -1
    s_add_u32 s98, s98, 16
    v_mul_u32_u24 v4, 4682, v1
    v_lshrrev_b32 v4, 16, v4
    v_mul_u32_u24 v4, 1792, v4
    v_add_u32 v4, v4, v15
    s_mul_i32 s96, s5, 16
    s_add_u32 s96, s96, s98
    s_and_b32 s96, s96, 127
    s_mul_i32 s96, s96, 14336
    s_bfm_b64 exec, 56, 0
    buffer_load_dword v31, v4, s[20:23], s96 offen
    s_mov_b64 exec, -1
    s_add_u32 s98, s98, 16
    s_sub_u32 s98, s98, 128
    s_lshr_b32 s61, s98, 1
    s_mul_i32 s61, s61, 200704
    s_and_b32 s62, s98, 1
    s_mul_i32 s62, s62, 14336
    s_add_u32 s61, s61, s62
    s_bfm_b64 exec, 56, 0
    s_mov_b64 exec, -1
L_spare:
    s_waitcnt vmcnt(0)
    s_barrier
    s_and_b32 s60, s6, 1
    s_lshr_b32 s61, s6, 4
    s_lshl_b32 s61, s61, 1
    s_add_u32 s60, s60, s61
    s_lshl_b32 s60, s60, 3
    s_add_u32 s60, s60, s4
    v_lshlrev_b32 v4, 7, v1
    s_lshr_b32 s61, s60, 2
    s_mul_i32 s61, s61, 200704
    s_and_b32 s62, s60, 3
    s_mul_i32 s62, s62, 7168
    s_add_u32 s61, s61, s62
    s_add_u32 s61, s61, 0
    s_bfm_b64 exec, 56, 0
    buffer_load_dword v31, v4, s[28:31], s61 offen
    s_add_u32 s61, s61, 28672
    buffer_load_dword v31, v4, s[28:31], s61 offen
    s_add_u32 s61, s61, 28672
    buffer_load_dword v31, v4, s[28:31], s61 offen
    s_add_u32 s61, s61, 28672
    buffer_load_dword v31, v4, s[28:31], s61 offen
    s_add_u32 s61, s61, 28672
    buffer_load_dword v31, v4, s[28:31], s61 offen
    s_add_u32 s61, s61, 28672
    buffer_load_dword v31, v4, s[28:31], s61 offen
    s_add_u32 s61, s61, 28672
    buffer_load_dword v31, v4, s[28:31], s61 offen
    s_add_u32 s61, s61, 28672
    s_mov_b64 exec, -1
    s_branch L_fin2
L_helre_4:
    s_add_u32 s78, s78, 1
    s_cmp_ge_u32 s78, 200000
    s_cbranch_scc1 L_helback_5
    s_sleep 2
    buffer_load_dword v14, v124, s[36:39], s54 offen sc1
    s_waitcnt vmcnt(0)
    s_branch L_hel_3
L_helre_13:
    s_add_u32 s78, s78, 1
    s_cmp_ge_u32 s78, 200000
    s_cbranch_scc1 L_helback_14
    s_sleep 2
    buffer_load_dword v14, v30, s[36:39], s54 offen sc1
    s_waitcnt vmcnt(0)
    s_branch L_hel_12
L_sfre_32:
    s_add_u32 s78, s78, 1
    s_cmp_ge_u32 s78, 200000
    s_cbranch_scc1 L_sfok_33
    s_sleep 2
    buffer_load_dword v12, v13, s[36:39], s62 offen sc1
    s_waitcnt vmcnt(0)
    s_branch L_sf_31
L_slow_6:
    buffer_store_dwordx4 v[56:59], v16, s[36:39], s84 offen sc1
    s_branch L_back_7
L_slow_8:
    buffer_store_dwordx4 v[60:63], v16, s[36:39], s87 offen sc1
    s_branch L_back_9
L_slow_10:
    buffer_store_dword v4, v5, s[36:39], s85 offen sc1
    s_branch L_back_11
L_slow_17:
    buffer_store_dwordx4 v[160:163], v12, s[36:39], s87 offen offset:0 sc1
    s_branch L_back_18
L_slow_19:
    buffer_store_dwordx4 v[164:167], v12, s[36:39], s87 offen offset:256 sc1
    s_branch L_back_20
L_slow_21:
    buffer_store_dword v10, v11, s[36:39], s99 offen sc1
    s_branch L_back_22
L_slow_23:
    buffer_store_dwordx2 v[232:233], v16, s[36:39], s84 offen offset:0 sc1
    s_branch L_back_24
L_slow_25:
    buffer_store_dwordx2 v[248:249], v16, s[36:39], s84 offen offset:1792 sc1
    s_branch L_back_26
L_slow_27:
    buffer_store_dword v12, v13, s[36:39], s99 offen sc1
    s_branch L_back_28
L_slow_35:
    buffer_store_dword v12, v13, s[36:39], s85 offen sc1
    s_branch L_back_36
L_fin2:
    s_endpgm
.section .rodata,"a"
.p2align 6
.amdhsa_kernel sequential_preLN__sliding_local_dilated__glu_gated_glu__prompt_kernel
  .amdhsa_next_free_vgpr 256
  .amdhsa_next_free_sgpr 102
  .amdhsa_accum_offset 256
  .amdhsa_group_segment_fixed_size 0
  .amdhsa_kernarg_size 80
  .amdhsa_user_sgpr_count 2
  .amdhsa_user_sgpr_kernarg_segment_ptr 1
  .amdhsa_system_sgpr_workgroup_id_x 1
.end_amdhsa_kernel
```
